```python
import torch

def _softmax(x, axis=-1):
    return torch.softmax(x, dim=axis)
def _gelu(x):
    return torch.nn.functional.gelu(x, approximate="tanh")
def _silu(x):
    return torch.nn.functional.silu(x)
def _sigmoid(x):
    return torch.sigmoid(x)
def _layernorm(x, axis=-1, eps=1e-5):
    m = x.mean(dim=axis, keepdim=True)
    v = x.var(dim=axis, keepdim=True, unbiased=False)
    return (x - m) / torch.sqrt(v + eps)
def _scatter_add(tgt, idx, src, axis=0):
    return tgt.clone().index_add_(axis, idx, src)
def _segment_sum(src, seg, n):
    out = torch.zeros((n,) + src.shape[1:], dtype=src.dtype)
    return out.index_add_(0, seg, src)
def _pad(x, pw):
    flat = tuple(v for pair in reversed(pw) for v in pair)
    return torch.nn.functional.pad(x, flat)

kernel_name = 'gated_mix__spectral_gfnet__glu_gated_reglu__prompt'

def setup_inputs():

    _w = (lambda a: (lambda t: t.to(torch.bfloat16) if t.is_floating_point() else t)(torch.as_tensor(a)))
    def _A_setup():
        B, S, D = 1, 2048, 576
        Df = D // 2 + 1
        return {
            "x": _w((lambda *s: torch.randn(*s, dtype=torch.bfloat16) * 0.05)(B, S, D)),
            "w_r": _w((lambda *s: torch.randn(*s, dtype=torch.bfloat16) * 0.05)(S, Df) * 0.02),
            "w_i": _w((lambda *s: torch.randn(*s, dtype=torch.bfloat16) * 0.05)(S, Df) * 0.02),
        }
    _A_in = _A_setup()

    def _B_setup():
        B, S, D, F = 1, 2048, 576, 4608
        return {
            "x": _w((lambda *s: torch.randn(*s, dtype=torch.bfloat16) * 0.05)(B, S, D)),
            "W_gate": _w((lambda *s: torch.randn(*s, dtype=torch.bfloat16) * 0.2)(D, F) * (2.0 / D) ** 0.5),
            "W_up": _w((lambda *s: torch.randn(*s, dtype=torch.bfloat16) * 0.2)(D, F) * (2.0 / D) ** 0.5),
            "W_down": _w((lambda *s: torch.randn(*s, dtype=torch.bfloat16) * 0.2)(F, D) * (1.0 / F) ** 0.5),
        }
    _B_in = _B_setup()

    return {
        "A_x": _A_in["x"],
        "A_w_r": _A_in["w_r"],
        "A_w_i": _A_in["w_i"],
        "B_x": _B_in["x"],
        "B_W_gate": _B_in["W_gate"],
        "B_W_up": _B_in["W_up"],
        "B_W_down": _B_in["W_down"],
        "gate_w": _w((lambda *s: torch.randn(*s, dtype=torch.bfloat16) * 0.05)(576) * 16.0),
    }

def reference(A_x, A_w_r, A_w_i, B_x, B_W_gate, B_W_up, B_W_down, gate_w):
    def _A_ref(x, w_r, w_i):
        B, S, D = x.shape
        X = (lambda x, axes=(-2,-1): torch.fft.rfft2(x.float(), dim=axes))(x, axes=(-2, -1))
        W = w_r + 1j * w_i
        X = X * W
        y = (lambda x, s, axes=(-2,-1): torch.fft.irfft2(x, s=s, dim=axes).to(torch.bfloat16))(X, (S, D), axes=(-2, -1))
        return y

    def _B_ref(x, W_gate, W_up, W_down):
        gate = torch.einsum("bsd,df->bsf", x, W_gate)
        up = torch.einsum("bsd,df->bsf", x, W_up)
        gate = gate * (lambda x, dt: x.to(dt))(gate > 0, gate.dtype)
        h = gate * up
        return torch.einsum("bsf,fd->bsd", h, W_down)

    x = A_x
    g = _sigmoid((x * gate_w).sum(-1, keepdims=True))
    a = _A_ref(x, A_w_r, A_w_i)
    b = _B_ref(x, B_W_gate, B_W_up, B_W_down)
    return g * a + (1 - g) * b
```

```asm
; @launch grid=(256,1,1) block=(512,1,1) lds=163840
.amdgcn_target "amdgcn-amd-amdhsa--gfx950"
.text
.globl gated_mix__spectral_gfnet__glu_gated_reglu__prompt_kernel
.p2align 8
.type gated_mix__spectral_gfnet__glu_gated_reglu__prompt_kernel,@function
gated_mix__spectral_gfnet__glu_gated_reglu__prompt_kernel:
    s_cmp_ge_u32 s2, 256
    s_cbranch_scc1 K2_END
    s_setprio 3
    s_cmp_ge_u32 s2, 8
    s_cbranch_scc1 K1_NOCP
    s_getpc_b64 s[6:7]
K1_PC1:
    v_lshlrev_b32 v2, 7, v0
    v_cmp_gt_u32 vcc, K2_END - gated_mix__spectral_gfnet__glu_gated_reglu__prompt_kernel, v2
    s_sub_u32 s6, s6, K1_PC1 - gated_mix__spectral_gfnet__glu_gated_reglu__prompt_kernel
    s_subb_u32 s7, s7, 0
    s_and_saveexec_b64 s[8:9], vcc
    v_mov_b32 v3, s7
    v_add_co_u32 v2, vcc, s6, v2
    s_nop 1
    v_addc_co_u32 v3, vcc, 0, v3, vcc
    s_cbranch_execz K1_PC1_E
    global_load_dword v95, v[2:3], off
K1_PC1_E:
    s_mov_b64 exec, -1
K1_NOCP:
    s_load_dwordx4 s[4:7], s[0:1], 0
    s_load_dwordx4 s[12:15], s[0:1], 32
    s_load_dwordx2 s[8:9], s[0:1], 16
    s_load_dwordx2 s[10:11], s[0:1], 80
    s_load_dwordx4 s[92:95], s[0:1], 48
    s_load_dwordx4 s[76:79], s[0:1], 64
    v_and_b32 v1, 63, v0
    v_lshrrev_b32 v2, 6, v0
    s_and_b32 s52, s2, 7
    s_lshr_b32 s53, s2, 3
    v_readfirstlane_b32 s36, v2
    s_and_b32 s37, s52, 1
    s_lshl_b32 s37, s37, 2
    s_and_b32 s54, s53, 3
    s_add_u32 s37, s37, s54
    s_lshr_b32 s38, s52, 1
    s_lshl_b32 s38, s38, 3
    s_lshr_b32 s54, s53, 2
    s_add_u32 s38, s38, s54
    s_lshr_b32 s39, s36, 2
    s_and_b32 s40, s36, 3
    v_lshrrev_b32 v20, 3, v1
    s_mov_b32 s52, 73728
    v_mul_lo_u32 v20, v20, s52
    s_lshl_b32 s53, s37, 3
    s_add_u32 s53, s53, s36
    s_mul_i32 s53, s53, 1152
    v_add_u32 v20, s53, v20
    v_lshrrev_b32 v21, 4, v1
    v_and_b32 v22, 7, v1
    v_xor_b32 v21, v21, v22
    v_lshl_add_u32 v2, v21, 4, v20
    v_xor_b32 v21, 4, v21
    v_lshl_add_u32 v3, v21, 4, v20
    v_add_u32 v3, 589824, v3
    s_mul_i32 s52, s40, 73728
    s_mul_i32 s53, s38, 288
    s_add_u32 s52, s52, s53
    s_mov_b32 s54, 8928
    v_add_u32 v20, 0, v1
    v_mul_u32_u24 v21, 3641, v20
    v_lshrrev_b32 v21, 16, v21
    v_mul_u32_u24 v21, s54, v21
    v_lshl_add_u32 v21, v20, 4, v21
    v_add_u32 v4, s52, v21
    v_add_u32 v20, 64, v1
    v_mul_u32_u24 v21, 3641, v20
    v_lshrrev_b32 v21, 16, v21
    v_mul_u32_u24 v21, s54, v21
    v_lshl_add_u32 v21, v20, 4, v21
    v_add_u32 v5, s52, v21
    v_add_u32 v20, 128, v1
    v_mul_u32_u24 v21, 3641, v20
    v_lshrrev_b32 v21, 16, v21
    v_mul_u32_u24 v21, s54, v21
    v_lshl_add_u32 v21, v20, 4, v21
    v_add_u32 v6, s52, v21
    s_mov_b32 s41, 0
    s_mov_b32 s42, 1179648
    s_mov_b32 s43, 0
    s_lshl_b32 s44, s36, 12
    s_mul_i32 s45, s36, 2432
    s_add_u32 s45, s45, 65536
    s_waitcnt lgkmcnt(0)
    s_mov_b32 s16, s4
    s_and_b32 s17, s5, 0xffff
    s_mov_b32 s18, 0x240000
    s_mov_b32 s19, 0x20000
    s_cmp_eq_u32 s39, 0
    s_cselect_b32 s20, s12, s14
    s_cselect_b32 s21, s13, s15
    s_and_b32 s21, s21, 0xffff
    s_mov_b32 s22, 0x510000
    s_mov_b32 s23, 0x20000
    s_add_u32 m0, s44, 0
    s_nop 0
    buffer_load_dwordx4 v2, s[16:19], s41 offen lds
    s_add_u32 m0, s44, 1024
    s_nop 0
    buffer_load_dwordx4 v3, s[16:19], s41 offen lds
    s_add_u32 m0, s44, 2048
    s_nop 0
    buffer_load_dwordx4 v2, s[16:19], s42 offen lds
    s_add_u32 m0, s44, 3072
    s_nop 0
    buffer_load_dwordx4 v3, s[16:19], s42 offen lds
    s_add_u32 s41, s41, 128
    s_xor_b32 s44, s44, 32768
    s_cmp_ge_u32 s41, 1152
    s_cselect_b32 s41, 0x40000000, s41
    s_add_u32 s42, s41, 1179648
    s_add_u32 m0, s45, 0
    s_nop 0
    buffer_load_dwordx4 v4, s[20:23], s43 offen lds
    s_add_u32 m0, s45, 1024
    s_nop 0
    buffer_load_dwordx4 v5, s[20:23], s43 offen lds
    s_add_u32 m0, s45, 2048
    s_mov_b64 exec, 0xffff
    buffer_load_dwordx4 v6, s[20:23], s43 offen lds
    s_mov_b64 exec, -1
    s_add_u32 s43, s43, 294912
    s_add_u32 s45, s45, 19456
    s_cmp_ge_u32 s45, 143360
    s_cselect_b32 s52, 77824, 0
    s_sub_u32 s45, s45, s52
    s_setprio 0
    s_cmp_eq_u32 s39, 0
    s_cselect_b32 s28, s6, s8
    s_cselect_b32 s29, s7, s9
    s_and_b32 s29, s29, 0xffff
    s_mov_b32 s30, 0x121000
    s_mov_b32 s31, 0x20000
    s_lshr_b32 s58, s2, 4
    s_lshl_b32 s58, s58, 2
    s_add_u32 s58, s58, s40
    s_lshl_b32 s58, s58, 2
    s_bfe_u32 s53, s2, 0x20002
    s_add_u32 s58, s58, s53
    s_mul_i32 s58, s58, 4624
    s_and_b32 s53, s2, 3
    s_mul_i32 s53, s53, 146
    s_add_u32 s61, s58, s53
    v_add_u32 v20, 0, v1
    v_mul_u32_u24 v21, 6554, v20
    v_lshrrev_b32 v21, 16, v21
    v_mul_u32_u24 v21, 418, v21
    v_lshl_add_u32 v29, v20, 4, v21
    v_add_u32 v20, 64, v1
    v_mul_u32_u24 v21, 6554, v20
    v_lshrrev_b32 v21, 16, v21
    v_mul_u32_u24 v21, 418, v21
    v_lshl_add_u32 v30, v20, 4, v21
    v_lshlrev_b32 v19, 4, v1
    s_mul_i32 s53, s36, 1280
    s_add_u32 s60, s53, 143360
    s_lshl_b32 s3, s2, 3
    s_add_u32 s3, s3, s36
    s_mul_i32 s3, s3, 2688
    v_lshlrev_b32 v90, 7, v1
    s_mov_b32 s96, s92
    s_and_b32 s97, s93, 0xffff
    s_mov_b32 s98, 0x510000
    s_mov_b32 s99, 0x20000
    s_cmp_lt_u32 s38, 18
    s_cselect_b32 s53, 0, s39
    s_cmp_eq_u32 s53, 0
    s_cbranch_scc1 K1_NOGW
    s_mov_b32 s56, s94
    s_and_b32 s57, s95, 0xffff
    s_mov_b32 s58, 0x480
    s_mov_b32 s59, 0x20000
    s_mov_b32 m0, 159744
    s_nop 0
    buffer_load_dwordx4 v19, s[56:59], 0 offen lds
    s_mov_b64 exec, 0xff
    buffer_load_dwordx4 v19, s[56:59], 0 offen offset:1024 lds
    s_mov_b64 exec, -1
    s_sub_u32 s53, s38, 18
    s_and_b32 s53, s53, 7
    s_lshl_b32 s53, s53, 2
    s_add_u32 s53, s53, s40
    s_lshl_b32 s53, s53, 3
    v_lshrrev_b32 v22, 3, v1
    v_add_u32 v22, s53, v22
    v_bfe_u32 v23, v22, 1, 3
    v_and_b32 v24, 7, v1
    v_xor_b32 v23, v23, v24
    v_lshlrev_b32 v22, 7, v22
    v_lshl_add_u32 v242, v23, 4, v22
    v_lshlrev_b32 v24, 4, v24
    v_add_u32 v243, 159744, v24
    v_mov_b32 v240, 0
    v_mov_b32 v241, 0
K1_NOGW:
    s_add_u32 m0, s45, 0
    s_nop 0
    buffer_load_dwordx4 v4, s[20:23], s43 offen lds
    s_add_u32 m0, s45, 1024
    s_nop 0
    buffer_load_dwordx4 v5, s[20:23], s43 offen lds
    s_add_u32 m0, s45, 2048
    s_mov_b64 exec, 0xffff
    buffer_load_dwordx4 v6, s[20:23], s43 offen lds
    s_mov_b64 exec, -1
    s_add_u32 s43, s43, 294912
    s_add_u32 s45, s45, 19456
    s_cmp_ge_u32 s45, 143360
    s_cselect_b32 s52, 77824, 0
    s_sub_u32 s45, s45, s52
    s_add_u32 m0, s44, 0
    s_nop 0
    buffer_load_dwordx4 v2, s[16:19], s41 offen lds
    s_add_u32 m0, s44, 1024
    s_nop 0
    buffer_load_dwordx4 v3, s[16:19], s41 offen lds
    s_mov_b32 s24, s10
    s_and_b32 s25, s11, 0xffff
    s_mov_b32 s26, 0x234c580
    s_mov_b32 s27, 0x20000
    s_mov_b64 s[100:101], s[76:77]
    s_mov_b32 s76, s78
    s_and_b32 s77, s79, 0xffff
    s_mov_b32 s78, 0x100
    s_mov_b32 s79, 0x20000
    v_mul_u32_u24 v22, 21846, v1
    v_lshrrev_b32 v22, 16, v22
    v_mul_u32_u24 v23, 3, v22
    v_sub_u32 v23, v1, v23
    s_mov_b32 s59, 73728
    v_mul_lo_u32 v22, v22, s59
    v_lshl_add_u32 v22, v23, 7, v22
    s_mul_i32 s59, s40, 144
    s_add_u32 s59, s59, s37
    s_mul_i32 s59, s59, 9216
    s_mul_i32 s32, s38, 288
    s_andn2_b32 s32, s32, 127
    s_add_u32 s59, s59, s32
    v_add_u32 v91, s59, v22
    s_lshl_b32 s32, s38, 3
    s_add_u32 s32, s32, s37
    s_lshl_b32 s32, s32, 3
    s_add_u32 s32, s32, s36
    s_mul_i32 s32, s32, 1152
    s_sub_u32 s33, 9, s40
    s_min_u32 s33, s33, 8
    s_or_b32 s59, s2, s36
    s_cmp_lg_u32 s59, 0
    s_cbranch_scc1 K1_NOTAG
    v_mov_b32 v22, 37012736
    buffer_load_dword v23, v22, s[24:27], 0 offen sc1
    s_waitcnt vmcnt(0)
    v_add_u32 v23, 1, v23
    v_max_u32 v23, 1, v23
    v_mov_b32 v24, 0
    s_mov_b64 exec, 1
    buffer_store_dword v23, v22, s[24:27], 0 offen sc1
    buffer_store_dword v23, v24, s[76:79], 0 offen sc1
    s_mov_b64 exec, -1
K1_NOTAG:
    v_lshrrev_b32 v22, 3, v0
    v_and_b32 v23, 7, v0
    v_mul_u32_u24 v24, 160, v23
    v_lshl_add_u32 v24, v22, 1, v24
    v_add_u32 v18, 143360, v24
    v_mul_u32_u24 v24, 8448, v22
    v_lshl_add_u32 v11, v23, 4, v24
    s_and_b32 s59, s2, 3
    s_cmp_eq_u32 s59, 3
    s_cselect_b32 s15, 48, 72
    s_mul_i32 s48, s59, 616704
    s_lshr_b32 s59, s2, 2
    s_lshl_b32 s59, s59, 7
    s_add_u32 s48, s48, s59
    s_add_u32 s48, s48, 21438464
    s_lshl_b32 s63, s37, 2
    s_lshr_b32 s59, s38, 3
    s_add_u32 s63, s63, s59
    s_lshl_b32 s63, s63, 1
    s_lshr_b32 s59, s40, 1
    s_add_u32 s63, s63, s59
    s_lshl_b32 s63, s63, 3
    s_and_b32 s59, s38, 7
    s_add_u32 s63, s63, s59
    s_lshl_b32 s63, s63, 1
    s_add_u32 s63, s63, s39
    s_lshl_b32 s63, s63, 1
    s_and_b32 s59, s40, 1
    s_add_u32 s63, s63, s59
    s_lshl_b32 s63, s63, 2
    s_add_u32 s63, s63, 36954368
    s_and_b32 s52, s38, 1
    s_cmp_eq_u32 s52, 1
    s_cselect_b32 s53, 1, 4
    s_cselect_b32 s54, 5, 0
    s_cselect_b32 s55, 0, 256
    s_cmp_eq_u32 s39, 0
    s_cselect_b32 s53, s53, s54
    s_mul_i32 s49, s38, 9
    s_add_u32 s49, s49, s53
    s_lshl_b32 s53, s53, 5
    v_lshrrev_b32 v22, 4, v1
    v_mul_u32_u24 v23, 2432, v22
    v_bfe_u32 v24, v1, 2, 2
    v_mul_u32_u24 v24, 288, v24
    v_and_b32 v25, 3, v1
    v_lshlrev_b32 v25, 3, v25
    v_add3_u32 v23, v23, v24, v25
    v_add_u32 v7, s53, v23
    v_add_u32 v9, s55, v23
    s_mov_b32 s46, 65536
    v_add_u32 v8, s46, v7
    v_add_u32 v10, s46, v9
    v_and_b32 v24, 15, v1
    v_lshlrev_b32 v23, 7, v24
    s_lshl_b32 s52, s40, 13
    v_add_u32 v23, s52, v23
    v_lshrrev_b32 v25, 1, v24
    v_xor_b32 v25, v25, v22
    v_lshl_add_u32 v88, v25, 4, v23
    v_xor_b32 v89, 64, v88
    s_mov_b32 s50, 0x3ae38e39
    s_mov_b32 s51, 0xc4100000
    s_lshl_b32 s52, s38, 1
    s_and_b32 s53, s40, 1
    s_add_u32 s52, s52, s53
    s_lshl_b32 s52, s52, 4
    v_add_u32 v23, s52, v24
    v_and_b32 v25, 1, v23
    v_cvt_f32_u32 v25, v25
    v_mul_f32 v15, 0x3e800000, v25
    v_lshrrev_b32 v25, 1, v23
    v_cmp_eq_u32 vcc, 1, v23
    v_mov_b32 v27, 288
    s_lshr_b32 s54, s40, 1
    v_cndmask_b32 v25, v25, v27, vcc
    v_cndmask_b32 v15, v15, 0, vcc
    v_lshlrev_b32 v27, 1, v22
    v_add_u32 v27, s54, v27
    v_lshlrev_b32 v27, 2, v27
    v_cvt_f32_u32 v27, v27
    v_cvt_f32_u32 v28, v25
    v_mul_f32 v12, s50, v28
    v_mul_f32 v14, 0x42000000, v28
    v_mul_f32 v13, v27, v28
    v_lshlrev_b32 v17, 4, v1
    v_add_u32 v17, 155648, v17
    s_lshl_b32 s53, s53, 10
    s_lshl_b32 s54, s54, 3
    s_add_u32 s53, s53, s54
    v_add_u32 v16, s53, v17
    s_cmp_eq_u32 s39, 0
    s_cbranch_scc1 K1_NOF
    s_cmp_lt_u32 s38, 18
    s_cbranch_scc1 K1_FG
    s_mul_i32 s57, s37, 14
    s_add_u32 s57, s57, s38
    s_sub_u32 s57, s57, 18
    s_lshl_b32 s57, s57, 2
    s_add_u32 s57, s57, s40
    s_mov_b32 s55, 58255
    s_mov_b32 s56, 36274432
K1_GF:
    s_lshl_b32 s52, s57, 6
    v_add_u32 v52, s52, v1
    v_mul_lo_u32 v53, v52, s55
    v_lshrrev_b32 v53, 22, v53
    v_mul_u32_u24 v54, 72, v53
    v_sub_u32 v54, v52, v54
    v_lshlrev_b32 v54, 3, v54
    v_and_b32 v55, 1, v53
    v_cvt_f32_u32 v55, v55
    v_mul_f32 v55, 0x3e800000, v55
    v_lshrrev_b32 v56, 1, v53
    v_cmp_eq_u32 vcc, 1, v53
    v_mov_b32 v57, 288
    v_lshlrev_b32 v52, 4, v52
    v_cndmask_b32 v56, v56, v57, vcc
    v_cndmask_b32 v55, v55, 0, vcc
    v_mul_u32_u24 v57, v56, v54
    v_cvt_f32_u32 v57, v57
    v_cvt_f32_u32 v56, v56
    v_mul_f32 v56, s50, v56
    v_mul_f32 v66, s50, v57
    v_rndne_f32 v66, v66
    v_fma_f32 v66, v66, s51, v57
    v_fma_f32 v58, v66, s50, v55
    v_add_f32 v59, v58, v56
    v_fma_f32 v60, v56, 2.0, v58
    v_fma_f32 v62, v56, 4.0, v58
    v_add_f32 v61, v60, v56
    v_add_f32 v63, v62, v56
    v_fma_f32 v64, v56, 2.0, v62
    v_add_f32 v65, v64, v56
    v_cmp_gt_u32 vcc, 2, v53
    v_mov_b32 v57, 1.0
    v_cos_f32 v58, v58
    v_cos_f32 v59, v59
    v_cos_f32 v60, v60
    v_cos_f32 v61, v61
    v_cos_f32 v62, v62
    v_cos_f32 v63, v63
    v_cos_f32 v64, v64
    v_cos_f32 v65, v65
    v_cndmask_b32 v57, v57, 0.5, vcc
    v_mul_f32 v58, v57, v58
    v_mul_f32 v59, v57, v59
    v_mul_f32 v60, v57, v60
    v_mul_f32 v61, v57, v61
    v_mul_f32 v62, v57, v62
    v_mul_f32 v63, v57, v63
    v_mul_f32 v64, v57, v64
    v_mul_f32 v65, v57, v65
    v_cvt_pk_bf16_f32 v70, v58, v59
    v_cvt_pk_bf16_f32 v71, v60, v61
    v_cvt_pk_bf16_f32 v72, v62, v63
    v_cvt_pk_bf16_f32 v73, v64, v65
    buffer_store_dwordx4 v[70:73], v52, s[24:27], s56 offen sc1
    s_add_u32 s57, s57, 448
    s_cmp_lt_u32 s57, 648
    s_cbranch_scc1 K1_GF
    s_branch K1_NOG
K1_FG:
    v_mul_f32 v24, s50, v13
    v_rndne_f32 v24, v24
    v_fma_f32 v24, v24, s51, v13
    v_fma_f32 v20, v24, s50, v15
    v_add_f32 v13, v13, v14
    v_add_f32 v21, v20, v12
    v_fma_f32 v22, v12, 2.0, v20
    v_add_f32 v23, v22, v12
    v_cos_f32 v20, v20
    v_cos_f32 v21, v21
    v_cos_f32 v22, v22
    v_cos_f32 v23, v23
    v_cvt_pk_bf16_f32 v26, v20, v21
    v_cvt_pk_bf16_f32 v27, v22, v23
    ds_write_b64 v16, v[26:27] offset:0
    v_mul_f32 v24, s50, v13
    v_rndne_f32 v24, v24
    v_fma_f32 v24, v24, s51, v13
    v_fma_f32 v20, v24, s50, v15
    v_add_f32 v13, v13, v14
    v_add_f32 v21, v20, v12
    v_fma_f32 v22, v12, 2.0, v20
    v_add_f32 v23, v22, v12
    v_cos_f32 v20, v20
    v_cos_f32 v21, v21
    v_cos_f32 v22, v22
    v_cos_f32 v23, v23
    v_cvt_pk_bf16_f32 v26, v20, v21
    v_cvt_pk_bf16_f32 v27, v22, v23
    ds_write_b64 v16, v[26:27] offset:2048
    v_xor_b32 v16, 4096, v16
K1_NOG:
    s_setprio 1
K1_NOF:
    s_lshl_b32 s52, s37, 4
    s_lshl_b32 s53, s40, 2
    s_add_u32 s52, s52, s53
    s_mul_i32 s53, s52, 148480
    s_lshl_b32 s54, s49, 9
    s_add_u32 s4, s53, s54
    s_mul_i32 s54, s38, 9
    s_and_b32 s56, s38, 1
    s_cmp_eq_u32 s56, 0
    s_cselect_b32 s57, 8, 0
    s_add_u32 s54, s54, s57
    s_lshr_b32 s54, s54, 1
    s_lshl_b32 s54, s54, 10
    s_add_u32 s8, s53, s54
    s_lshl_b32 s56, s56, 9
    s_add_u32 s8, s8, s56
    s_add_u32 s5, s4, 148480
    s_add_u32 s9, s8, 148480
    s_add_u32 s6, s4, 296960
    s_add_u32 s10, s8, 296960
    s_add_u32 s7, s4, 445440
    s_add_u32 s11, s8, 445440
    s_mul_i32 s12, s38, 135168
    s_lshl_b32 s54, s52, 6
    s_add_u32 s12, s12, s54
    s_add_u32 s12, s12, 19005440
    s_mov_b32 s47, 8
    v_mov_b32 v96, 0
    v_mov_b32 v97, 0
    v_mov_b32 v98, 0
    v_mov_b32 v99, 0
    v_mov_b32 v100, 0
    v_mov_b32 v101, 0
    v_mov_b32 v102, 0
    v_mov_b32 v103, 0
    v_mov_b32 v104, 0
    v_mov_b32 v105, 0
    v_mov_b32 v106, 0
    v_mov_b32 v107, 0
    v_mov_b32 v108, 0
    v_mov_b32 v109, 0
    v_mov_b32 v110, 0
    v_mov_b32 v111, 0
    v_mov_b32 v112, 0
    v_mov_b32 v113, 0
    v_mov_b32 v114, 0
    v_mov_b32 v115, 0
    v_mov_b32 v116, 0
    v_mov_b32 v117, 0
    v_mov_b32 v118, 0
    v_mov_b32 v119, 0
    v_mov_b32 v120, 0
    v_mov_b32 v121, 0
    v_mov_b32 v122, 0
    v_mov_b32 v123, 0
    v_mov_b32 v124, 0
    v_mov_b32 v125, 0
    v_mov_b32 v126, 0
    v_mov_b32 v127, 0
    v_mov_b32 v128, 0
    v_mov_b32 v129, 0
    v_mov_b32 v130, 0
    v_mov_b32 v131, 0
    v_mov_b32 v132, 0
    v_mov_b32 v133, 0
    v_mov_b32 v134, 0
    v_mov_b32 v135, 0
    v_mov_b32 v136, 0
    v_mov_b32 v137, 0
    v_mov_b32 v138, 0
    v_mov_b32 v139, 0
    v_mov_b32 v140, 0
    v_mov_b32 v141, 0
    v_mov_b32 v142, 0
    v_mov_b32 v143, 0
    v_mov_b32 v144, 0
    v_mov_b32 v145, 0
    v_mov_b32 v146, 0
    v_mov_b32 v147, 0
    v_mov_b32 v148, 0
    v_mov_b32 v149, 0
    v_mov_b32 v150, 0
    v_mov_b32 v151, 0
    v_mov_b32 v152, 0
    v_mov_b32 v153, 0
    v_mov_b32 v154, 0
    v_mov_b32 v155, 0
    v_mov_b32 v156, 0
    v_mov_b32 v157, 0
    v_mov_b32 v158, 0
    v_mov_b32 v159, 0
    v_mov_b32 v160, 0
    v_mov_b32 v161, 0
    v_mov_b32 v162, 0
    v_mov_b32 v163, 0
    v_mov_b32 v164, 0
    v_mov_b32 v165, 0
    v_mov_b32 v166, 0
    v_mov_b32 v167, 0
    v_mov_b32 v168, 0
    v_mov_b32 v169, 0
    v_mov_b32 v170, 0
    v_mov_b32 v171, 0
    v_mov_b32 v172, 0
    v_mov_b32 v173, 0
    v_mov_b32 v174, 0
    v_mov_b32 v175, 0
    v_mov_b32 v176, 0
    v_mov_b32 v177, 0
    v_mov_b32 v178, 0
    v_mov_b32 v179, 0
    v_mov_b32 v180, 0
    v_mov_b32 v181, 0
    v_mov_b32 v182, 0
    v_mov_b32 v183, 0
    v_mov_b32 v184, 0
    v_mov_b32 v185, 0
    v_mov_b32 v186, 0
    v_mov_b32 v187, 0
    v_mov_b32 v188, 0
    v_mov_b32 v189, 0
    v_mov_b32 v190, 0
    v_mov_b32 v191, 0
    v_mov_b32 v192, 0
    v_mov_b32 v193, 0
    v_mov_b32 v194, 0
    v_mov_b32 v195, 0
    v_mov_b32 v196, 0
    v_mov_b32 v197, 0
    v_mov_b32 v198, 0
    v_mov_b32 v199, 0
    v_mov_b32 v200, 0
    v_mov_b32 v201, 0
    v_mov_b32 v202, 0
    v_mov_b32 v203, 0
    v_mov_b32 v204, 0
    v_mov_b32 v205, 0
    v_mov_b32 v206, 0
    v_mov_b32 v207, 0
    v_mov_b32 v208, 0
    v_mov_b32 v209, 0
    v_mov_b32 v210, 0
    v_mov_b32 v211, 0
    v_mov_b32 v212, 0
    v_mov_b32 v213, 0
    v_mov_b32 v214, 0
    v_mov_b32 v215, 0
    v_mov_b32 v216, 0
    v_mov_b32 v217, 0
    v_mov_b32 v218, 0
    v_mov_b32 v219, 0
    v_mov_b32 v220, 0
    v_mov_b32 v221, 0
    v_mov_b32 v222, 0
    v_mov_b32 v223, 0
    s_cmp_lt_u32 s38, 18
    s_cselect_b32 s52, 0, s39
    s_cmp_lg_u32 s52, 0
    s_cbranch_scc1 K1_Z
    v_mov_b32 v224, 0
    v_mov_b32 v225, 0
    v_mov_b32 v226, 0
    v_mov_b32 v227, 0
    v_mov_b32 v228, 0
    v_mov_b32 v229, 0
    v_mov_b32 v230, 0
    v_mov_b32 v231, 0
    v_mov_b32 v232, 0
    v_mov_b32 v233, 0
    v_mov_b32 v234, 0
    v_mov_b32 v235, 0
    v_mov_b32 v236, 0
    v_mov_b32 v237, 0
    v_mov_b32 v238, 0
    v_mov_b32 v239, 0
    v_mov_b32 v240, 0
    v_mov_b32 v241, 0
    v_mov_b32 v242, 0
    v_mov_b32 v243, 0
    v_mov_b32 v244, 0
    v_mov_b32 v245, 0
    v_mov_b32 v246, 0
    v_mov_b32 v247, 0
    v_mov_b32 v248, 0
    v_mov_b32 v249, 0
    v_mov_b32 v250, 0
    v_mov_b32 v251, 0
    v_mov_b32 v252, 0
    v_mov_b32 v253, 0
    v_mov_b32 v254, 0
    v_mov_b32 v255, 0
K1_Z:
    s_waitcnt vmcnt(2) lgkmcnt(0)
    s_barrier
    s_mov_b64 exec, 0x1ff
    buffer_load_dword v93, v90, s[16:19], s32 offen
    s_mov_b64 exec, -1
    s_cmp_eq_u32 s39, 0
    s_cbranch_scc1 K1_P0
    s_cmp_ge_u32 s38, 18
    s_cbranch_scc1 K1_P2
K1_P1:
    ds_read_b128 v[48:51], v88 offset:0
    ds_read_b128 v[52:55], v88 offset:2048
    ds_read_b128 v[56:59], v88 offset:4096
    ds_read_b128 v[60:63], v88 offset:6144
    ds_read_b64_tr_b16 v[32:33], v8 offset:0
    ds_read_b64_tr_b16 v[34:35], v8 offset:1152
    ds_read_b64_tr_b16 v[36:37], v8 offset:9728
    ds_read_b64_tr_b16 v[38:39], v8 offset:10880
K1_L1:
    s_waitcnt lgkmcnt(2)
    v_mfma_f32_16x16x32_bf16 v[96:99], v[32:35], v[48:51], v[96:99]
    ds_read_b128 v[64:67], v89 offset:0
    ds_read_b128 v[68:71], v89 offset:2048
    v_mfma_f32_16x16x32_bf16 v[100:103], v[32:35], v[52:55], v[100:103]
    ds_read_b64_tr_b16 v[40:41], v8 offset:32
    ds_read_b64_tr_b16 v[42:43], v8 offset:1184
    v_mfma_f32_16x16x32_bf16 v[104:107], v[32:35], v[56:59], v[104:107]
    ds_read_b64_tr_b16 v[44:45], v8 offset:9760
    ds_read_b64_tr_b16 v[46:47], v8 offset:10912
    v_mfma_f32_16x16x32_bf16 v[108:111], v[32:35], v[60:63], v[108:111]
    s_add_u32 m0, s44, 2048
    s_nop 0
    buffer_load_dwordx4 v2, s[16:19], s42 offen lds
    s_waitcnt lgkmcnt(6)
    v_mfma_f32_16x16x32_bf16 v[112:115], v[36:39], v[48:51], v[112:115]
    ds_read_b128 v[72:75], v89 offset:4096
    ds_read_b128 v[76:79], v89 offset:6144
    v_mfma_f32_16x16x32_bf16 v[116:119], v[36:39], v[52:55], v[116:119]
    v_xor_b32 v88, 32768, v88
    v_xor_b32 v89, 32768, v89
    v_mfma_f32_16x16x32_bf16 v[120:123], v[36:39], v[56:59], v[120:123]
    ds_read_b64_tr_b16 v[32:33], v8 offset:29216
    ds_read_b64_tr_b16 v[34:35], v8 offset:30368
    v_mfma_f32_16x16x32_bf16 v[124:127], v[36:39], v[60:63], v[124:127]
    s_add_u32 m0, s44, 3072
    s_nop 0
    buffer_load_dwordx4 v3, s[16:19], s42 offen lds
    s_add_u32 s41, s41, 128
    s_xor_b32 s44, s44, 32768
    s_cmp_ge_u32 s41, 1152
    s_cselect_b32 s41, 0x40000000, s41
    s_add_u32 s42, s41, 1179648
    s_waitcnt lgkmcnt(6)
    v_mfma_f32_16x16x32_bf16 v[128:131], v[40:43], v[48:51], v[128:131]
    ds_read_b64_tr_b16 v[36:37], v8 offset:64
    v_mfma_f32_16x16x32_bf16 v[132:135], v[40:43], v[52:55], v[132:135]
    ds_read_b64_tr_b16 v[38:39], v8 offset:1216
    v_mfma_f32_16x16x32_bf16 v[136:139], v[40:43], v[56:59], v[136:139]
    s_add_u32 m0, s45, 0
    s_nop 0
    buffer_load_dwordx4 v4, s[20:23], s43 offen lds
    v_mfma_f32_16x16x32_bf16 v[140:143], v[40:43], v[60:63], v[140:143]
    s_waitcnt lgkmcnt(2)
    v_mfma_f32_16x16x32_bf16 v[144:147], v[44:47], v[48:51], v[144:147]
    ds_read_b64_tr_b16 v[40:41], v8 offset:19520
    v_mul_f32 v24, s50, v13
    v_mfma_f32_16x16x32_bf16 v[144:147], v[32:35], v[64:67], v[144:147]
    v_rndne_f32 v24, v24
    v_mfma_f32_16x16x32_bf16 v[148:151], v[44:47], v[52:55], v[148:151]
    ds_read_b64_tr_b16 v[42:43], v8 offset:20672
    v_mfma_f32_16x16x32_bf16 v[148:151], v[32:35], v[68:71], v[148:151]
    v_fma_f32 v24, v24, s51, v13
    v_mfma_f32_16x16x32_bf16 v[152:155], v[44:47], v[56:59], v[152:155]
    s_add_u32 m0, s45, 1024
    s_nop 0
    buffer_load_dwordx4 v5, s[20:23], s43 offen lds
    v_mfma_f32_16x16x32_bf16 v[152:155], v[32:35], v[72:75], v[152:155]
    v_fma_f32 v20, v24, s50, v15
    v_mfma_f32_16x16x32_bf16 v[156:159], v[44:47], v[60:63], v[156:159]
    s_add_u32 m0, s45, 2048
    s_mov_b64 exec, 0xffff
    buffer_load_dwordx4 v6, s[20:23], s43 offen lds
    s_mov_b64 exec, -1
    s_add_u32 s43, s43, 294912
    s_add_u32 s45, s45, 19456
    s_cmp_ge_u32 s45, 143360
    s_cselect_b32 s52, 77824, 0
    s_sub_u32 s45, s45, s52
    v_mfma_f32_16x16x32_bf16 v[156:159], v[32:35], v[76:79], v[156:159]
    v_add_f32 v13, v13, v14
    s_waitcnt lgkmcnt(0)
    v_mfma_f32_16x16x32_bf16 v[160:163], v[36:39], v[48:51], v[160:163]
    ds_read_b64_tr_b16 v[44:45], v8 offset:9792
    v_add_f32 v21, v20, v12
    v_mfma_f32_16x16x32_bf16 v[160:163], v[40:43], v[64:67], v[160:163]
    ds_read_b64_tr_b16 v[46:47], v8 offset:10944
    v_mfma_f32_16x16x32_bf16 v[164:167], v[36:39], v[52:55], v[164:167]
    v_fma_f32 v22, v12, 2.0, v20
    ds_read_b64_tr_b16 v[32:33], v8 offset:29248
    v_mfma_f32_16x16x32_bf16 v[164:167], v[40:43], v[68:71], v[164:167]
    v_add_f32 v23, v22, v12
    v_mfma_f32_16x16x32_bf16 v[168:171], v[36:39], v[56:59], v[168:171]
    ds_read_b64_tr_b16 v[34:35], v8 offset:30400
    v_mfma_f32_16x16x32_bf16 v[168:171], v[40:43], v[72:75], v[168:171]
    v_cos_f32 v20, v20
    s_add_u32 m0, s45, 0
    s_nop 0
    buffer_load_dwordx4 v4, s[20:23], s43 offen lds
    v_mfma_f32_16x16x32_bf16 v[172:175], v[36:39], v[60:63], v[172:175]
    v_cos_f32 v21, v21
    v_mfma_f32_16x16x32_bf16 v[172:175], v[40:43], v[76:79], v[172:175]
    s_add_u32 m0, s45, 1024
    s_nop 0
    buffer_load_dwordx4 v5, s[20:23], s43 offen lds
    s_waitcnt lgkmcnt(0)
    v_mfma_f32_16x16x32_bf16 v[176:179], v[44:47], v[48:51], v[176:179]
    ds_read_b64_tr_b16 v[36:37], v8 offset:96
    v_cos_f32 v22, v22
    v_mfma_f32_16x16x32_bf16 v[176:179], v[32:35], v[64:67], v[176:179]
    ds_read_b64_tr_b16 v[38:39], v8 offset:1248
    v_mfma_f32_16x16x32_bf16 v[180:183], v[44:47], v[52:55], v[180:183]
    v_cos_f32 v23, v23
    v_mfma_f32_16x16x32_bf16 v[180:183], v[32:35], v[68:71], v[180:183]
    ds_read_b64_tr_b16 v[40:41], v8 offset:19552
    v_mfma_f32_16x16x32_bf16 v[184:187], v[44:47], v[56:59], v[184:187]
    v_cvt_pk_bf16_f32 v26, v20, v21
    ds_read_b64_tr_b16 v[42:43], v8 offset:20704
    v_mfma_f32_16x16x32_bf16 v[184:187], v[32:35], v[72:75], v[184:187]
    v_cvt_pk_bf16_f32 v27, v22, v23
    v_mfma_f32_16x16x32_bf16 v[188:191], v[44:47], v[60:63], v[188:191]
    s_add_u32 m0, s45, 2048
    s_mov_b64 exec, 0xffff
    buffer_load_dwordx4 v6, s[20:23], s43 offen lds
    s_mov_b64 exec, -1
    s_add_u32 s43, s43, 294912
    s_add_u32 s45, s45, 19456
    s_cmp_ge_u32 s45, 143360
    s_cselect_b32 s52, 77824, 0
    s_sub_u32 s45, s45, s52
    v_mfma_f32_16x16x32_bf16 v[188:191], v[32:35], v[76:79], v[188:191]
    ds_write_b64 v16, v[26:27] offset:0
    s_waitcnt lgkmcnt(1)
    v_mfma_f32_16x16x32_bf16 v[192:195], v[36:39], v[48:51], v[192:195]
    ds_read_b64_tr_b16 v[44:45], v8 offset:9824
    v_mul_f32 v24, s50, v13
    v_mfma_f32_16x16x32_bf16 v[192:195], v[40:43], v[64:67], v[192:195]
    ds_read_b64_tr_b16 v[46:47], v8 offset:10976
    v_mfma_f32_16x16x32_bf16 v[196:199], v[36:39], v[52:55], v[196:199]
    v_rndne_f32 v24, v24
    v_mfma_f32_16x16x32_bf16 v[196:199], v[40:43], v[68:71], v[196:199]
    ds_read_b64_tr_b16 v[32:33], v8 offset:29280
    v_mfma_f32_16x16x32_bf16 v[200:203], v[36:39], v[56:59], v[200:203]
    v_fma_f32 v24, v24, s51, v13
    ds_read_b64_tr_b16 v[34:35], v8 offset:30432
    v_mfma_f32_16x16x32_bf16 v[200:203], v[40:43], v[72:75], v[200:203]
    v_fma_f32 v20, v24, s50, v15
    v_mfma_f32_16x16x32_bf16 v[204:207], v[36:39], v[60:63], v[204:207]
    s_cmp_lg_u32 s47, s33
    s_cbranch_scc1 K1_S1_w
    s_mov_b32 exec_hi, 0x3fffff
    buffer_load_dword v94, v91, s[20:23], 0 offen
    s_mov_b32 exec_hi, -1
    s_branch K1_SE1
K1_S1_w:
    s_cmp_lg_u32 s47, 5
    s_cbranch_scc1 K1_S1_0
    s_mov_b32 m0, s60
    s_nop 0
    buffer_load_dwordx4 v29, s[28:31], s61 offen lds
    s_branch K1_SE1
K1_S1_0:
    s_cmp_lg_u32 s47, 4
    s_cbranch_scc1 K1_S1_1
    s_add_u32 m0, s60, 1024
    s_mov_b64 exec, 0xffff
    buffer_load_dwordx4 v30, s[28:31], s61 offen lds
    s_mov_b64 exec, -1
    s_branch K1_SE1
K1_S1_1:
    s_cmp_lg_u32 s47, 3
    s_cbranch_scc1 K1_S1_2
    s_mov_b64 exec, 0x1fffff
    buffer_load_dword v94, v90, s[96:99], s3 offen
    s_mov_b64 exec, -1
    s_branch K1_SE1
K1_S1_2:
    s_cmp_lg_u32 s47, 2
    s_cbranch_scc1 K1_S1_3
    v_mov_b32 v31, 0
    buffer_load_dword v31, v31, s[76:79], 0 offen sc1
    s_branch K1_SE1
K1_S1_3:
    s_cmp_lg_u32 s47, 1
    s_cbranch_scc1 K1_S1_4
    v_add_u32 v90, 540672, v11
    v_mov_b32 v91, 0x40000000
    v_cmp_gt_u32 vcc, s15, v0
    s_nop 1
    v_cndmask_b32 v90, v91, v90, vcc
    ds_read_u16 v80, v18 offset:0
    ds_read_u16 v84, v18 offset:5120
    ds_read_u16 v81, v18 offset:1280
    ds_read_u16 v85, v18 offset:6400
    ds_read_u16 v82, v18 offset:2560
    ds_read_u16 v86, v18 offset:7680
    ds_read_u16 v83, v18 offset:3840
    ds_read_u16 v87, v18 offset:8960
    s_waitcnt lgkmcnt(0)
    v_lshl_or_b32 v92, v84, 16, v80
    v_lshl_or_b32 v93, v85, 16, v81
    v_lshl_or_b32 v94, v86, 16, v82
    v_lshl_or_b32 v95, v87, 16, v83
    buffer_store_dwordx4 v[92:95], v11, s[24:27], s48 offen sc1
    s_branch K1_SE1
K1_S1_4:
    buffer_load_dword v95, v19, s[76:79], 0 offen
K1_SE1:
    v_mfma_f32_16x16x32_bf16 v[204:207], v[40:43], v[76:79], v[204:207]
    v_add_f32 v13, v13, v14
    s_waitcnt lgkmcnt(0)
    v_mfma_f32_16x16x32_bf16 v[208:211], v[44:47], v[48:51], v[208:211]
    ds_read_b128 v[36:39], v17 offset:0
    v_mfma_f32_16x16x32_bf16 v[208:211], v[32:35], v[64:67], v[208:211]
    v_add_f32 v21, v20, v12
    v_mfma_f32_16x16x32_bf16 v[212:215], v[44:47], v[52:55], v[212:215]
    v_fma_f32 v22, v12, 2.0, v20
    v_mfma_f32_16x16x32_bf16 v[212:215], v[32:35], v[68:71], v[212:215]
    v_add_f32 v23, v22, v12
    v_mfma_f32_16x16x32_bf16 v[216:219], v[44:47], v[56:59], v[216:219]
    ds_read_b128 v[40:43], v17 offset:2048
    v_mfma_f32_16x16x32_bf16 v[216:219], v[32:35], v[72:75], v[216:219]
    v_cos_f32 v20, v20
    v_mfma_f32_16x16x32_bf16 v[220:223], v[44:47], v[60:63], v[220:223]
    v_cos_f32 v21, v21
    v_mfma_f32_16x16x32_bf16 v[220:223], v[32:35], v[76:79], v[220:223]
    s_waitcnt lgkmcnt(0)
    v_mfma_f32_16x16x32_bf16 v[224:227], v[36:39], v[48:51], v[224:227]
    ds_read_b128 v[44:47], v17 offset:1024
    v_mfma_f32_16x16x32_bf16 v[224:227], v[40:43], v[64:67], v[224:227]
    v_cos_f32 v22, v22
    v_mfma_f32_16x16x32_bf16 v[228:231], v[36:39], v[52:55], v[228:231]
    v_cos_f32 v23, v23
    v_mfma_f32_16x16x32_bf16 v[228:231], v[40:43], v[68:71], v[228:231]
    v_cvt_pk_bf16_f32 v26, v20, v21
    v_mfma_f32_16x16x32_bf16 v[232:235], v[36:39], v[56:59], v[232:235]
    ds_read_b128 v[32:35], v17 offset:3072
    v_mfma_f32_16x16x32_bf16 v[232:235], v[40:43], v[72:75], v[232:235]
    v_cvt_pk_bf16_f32 v27, v22, v23
    v_mfma_f32_16x16x32_bf16 v[236:239], v[36:39], v[60:63], v[236:239]
    ds_write_b64 v16, v[26:27] offset:2048
    v_mfma_f32_16x16x32_bf16 v[236:239], v[40:43], v[76:79], v[236:239]
    v_xor_b32 v16, 4096, v16
    s_setprio 0
    s_waitcnt lgkmcnt(1)
    v_mfma_f32_16x16x32_bf16 v[240:243], v[44:47], v[48:51], v[240:243]
    ds_read_b64_tr_b16 v[36:37], v8 offset:19456
    v_mfma_f32_16x16x32_bf16 v[240:243], v[32:35], v[64:67], v[240:243]
    v_mfma_f32_16x16x32_bf16 v[244:247], v[44:47], v[52:55], v[244:247]
    ds_read_b64_tr_b16 v[38:39], v8 offset:20608
    v_mfma_f32_16x16x32_bf16 v[244:247], v[32:35], v[68:71], v[244:247]
    v_mfma_f32_16x16x32_bf16 v[248:251], v[44:47], v[56:59], v[248:251]
    ds_read_b64_tr_b16 v[40:41], v8 offset:29184
    v_mfma_f32_16x16x32_bf16 v[248:251], v[32:35], v[72:75], v[248:251]
    v_mfma_f32_16x16x32_bf16 v[252:255], v[44:47], v[60:63], v[252:255]
    ds_read_b64_tr_b16 v[42:43], v8 offset:30336
    v_mfma_f32_16x16x32_bf16 v[252:255], v[32:35], v[76:79], v[252:255]
    s_waitcnt lgkmcnt(2)
    v_mfma_f32_16x16x32_bf16 v[96:99], v[36:39], v[64:67], v[96:99]
    ds_read_b64_tr_b16 v[44:45], v8 offset:19488
    v_mfma_f32_16x16x32_bf16 v[100:103], v[36:39], v[68:71], v[100:103]
    ds_read_b64_tr_b16 v[46:47], v8 offset:20640
    v_mfma_f32_16x16x32_bf16 v[104:107], v[36:39], v[72:75], v[104:107]
    s_xor_b32 s46, s46, 0x9800
    v_add_u32 v8, s46, v7
    v_mfma_f32_16x16x32_bf16 v[108:111], v[36:39], v[76:79], v[108:111]
    v_xor_b32 v17, 4096, v17
    s_waitcnt vmcnt(1) lgkmcnt(0)
    s_barrier
    s_setprio 1
    v_mfma_f32_16x16x32_bf16 v[112:115], v[40:43], v[64:67], v[112:115]
    ds_read_b128 v[48:51], v88 offset:0
    ds_read_b128 v[52:55], v88 offset:2048
    ds_read_b128 v[56:59], v88 offset:4096
    v_mfma_f32_16x16x32_bf16 v[116:119], v[40:43], v[68:71], v[116:119]
    ds_read_b128 v[60:63], v88 offset:6144
    ds_read_b64_tr_b16 v[32:33], v8 offset:0
    v_mfma_f32_16x16x32_bf16 v[120:123], v[40:43], v[72:75], v[120:123]
    ds_read_b64_tr_b16 v[34:35], v8 offset:1152
    ds_read_b64_tr_b16 v[36:37], v8 offset:9728
    v_mfma_f32_16x16x32_bf16 v[124:127], v[40:43], v[76:79], v[124:127]
    ds_read_b64_tr_b16 v[38:39], v8 offset:10880
    s_add_u32 m0, s44, 0
    s_nop 0
    buffer_load_dwordx4 v2, s[16:19], s41 offen lds
    v_mfma_f32_16x16x32_bf16 v[128:131], v[44:47], v[64:67], v[128:131]
    s_add_u32 m0, s44, 1024
    s_nop 0
    buffer_load_dwordx4 v3, s[16:19], s41 offen lds
    v_mfma_f32_16x16x32_bf16 v[132:135], v[44:47], v[68:71], v[132:135]
    v_mfma_f32_16x16x32_bf16 v[136:139], v[44:47], v[72:75], v[136:139]
    v_mfma_f32_16x16x32_bf16 v[140:143], v[44:47], v[76:79], v[140:143]
    s_sub_u32 s47, s47, 1
    s_cmp_lg_u32 s47, 0
    s_cbranch_scc1 K1_L1
    v_lshlrev_b32 v2, 4, v1
    v_lshrrev_b32 v3, 4, v1
    v_mul_u32_u24 v3, 16896, v3
    v_and_b32 v28, 15, v1
    v_lshl_add_u32 v3, v28, 3, v3
    s_waitcnt lgkmcnt(2)
    v_mfma_f32_16x16x32_bf16 v[96:99], v[32:35], v[48:51], v[96:99]
    ds_read_b128 v[64:67], v89 offset:0
    ds_read_b128 v[68:71], v89 offset:2048
    v_mfma_f32_16x16x32_bf16 v[100:103], v[32:35], v[52:55], v[100:103]
    ds_read_b128 v[72:75], v89 offset:4096
    v_mfma_f32_16x16x32_bf16 v[104:107], v[32:35], v[56:59], v[104:107]
    ds_read_b128 v[76:79], v89 offset:6144
    ds_read_b128 v[40:43], v17 offset:0
    v_mfma_f32_16x16x32_bf16 v[108:111], v[32:35], v[60:63], v[108:111]
    ds_read_b128 v[44:47], v17 offset:2048
    s_waitcnt lgkmcnt(6)
    v_mfma_f32_16x16x32_bf16 v[112:115], v[36:39], v[48:51], v[112:115]
    ds_read_b128 v[32:35], v17 offset:1024
    v_mfma_f32_16x16x32_bf16 v[116:119], v[36:39], v[52:55], v[116:119]
    v_mfma_f32_16x16x32_bf16 v[120:123], v[36:39], v[56:59], v[120:123]
    v_mfma_f32_16x16x32_bf16 v[124:127], v[36:39], v[60:63], v[124:127]
    s_waitcnt lgkmcnt(1)
    v_mfma_f32_16x16x32_bf16 v[224:227], v[40:43], v[48:51], v[224:227]
    ds_read_b128 v[36:39], v17 offset:3072
    v_mfma_f32_16x16x32_bf16 v[224:227], v[44:47], v[64:67], v[224:227]
    v_mfma_f32_16x16x32_bf16 v[228:231], v[40:43], v[52:55], v[228:231]
    v_mfma_f32_16x16x32_bf16 v[228:231], v[44:47], v[68:71], v[228:231]
    v_mfma_f32_16x16x32_bf16 v[232:235], v[40:43], v[56:59], v[232:235]
    v_mfma_f32_16x16x32_bf16 v[232:235], v[44:47], v[72:75], v[232:235]
    v_mfma_f32_16x16x32_bf16 v[236:239], v[40:43], v[60:63], v[236:239]
    v_mfma_f32_16x16x32_bf16 v[236:239], v[44:47], v[76:79], v[236:239]
    s_waitcnt lgkmcnt(0)
    v_mfma_f32_16x16x32_bf16 v[240:243], v[32:35], v[48:51], v[240:243]
    ds_read_b64_tr_b16 v[40:41], v8 offset:32
    v_mfma_f32_16x16x32_bf16 v[240:243], v[36:39], v[64:67], v[240:243]
    v_mfma_f32_16x16x32_bf16 v[244:247], v[32:35], v[52:55], v[244:247]
    ds_read_b64_tr_b16 v[42:43], v8 offset:1184
    v_mfma_f32_16x16x32_bf16 v[244:247], v[36:39], v[68:71], v[244:247]
    v_mfma_f32_16x16x32_bf16 v[248:251], v[32:35], v[56:59], v[248:251]
    ds_read_b64_tr_b16 v[44:45], v8 offset:19488
    v_mfma_f32_16x16x32_bf16 v[248:251], v[36:39], v[72:75], v[248:251]
    v_mfma_f32_16x16x32_bf16 v[252:255], v[32:35], v[60:63], v[252:255]
    ds_read_b64_tr_b16 v[46:47], v8 offset:20640
    v_mfma_f32_16x16x32_bf16 v[252:255], v[36:39], v[76:79], v[252:255]
    s_waitcnt lgkmcnt(0)
    v_mfma_f32_16x16x32_bf16 v[128:131], v[40:43], v[48:51], v[128:131]
    ds_read_b64_tr_b16 v[32:33], v8 offset:9760
    ds_read_b64_tr_b16 v[34:35], v8 offset:10912
    ds_read_b64_tr_b16 v[36:37], v8 offset:29216
    v_mfma_f32_16x16x32_bf16 v[128:131], v[44:47], v[64:67], v[128:131]
    ds_read_b64_tr_b16 v[38:39], v8 offset:30368
    s_nop 3
    v_mfma_f32_16x16x32_bf16 v[132:135], v[40:43], v[52:55], v[132:135]
    s_add_u32 s13, s12, 0
    v_cvt_pk_bf16_f32 v80, v224, v225
    v_mfma_f32_16x16x32_bf16 v[132:135], v[44:47], v[68:71], v[132:135]
    v_cvt_pk_bf16_f32 v81, v228, v229
    buffer_store_dwordx2 v[80:81], v3, s[24:27], s13 offen offset:0 sc1
    v_mfma_f32_16x16x32_bf16 v[136:139], v[40:43], v[56:59], v[136:139]
    v_cvt_pk_bf16_f32 v82, v232, v233
    v_cvt_pk_bf16_f32 v83, v236, v237
    buffer_store_dwordx2 v[82:83], v3, s[24:27], s13 offen offset:128 sc1
    v_mfma_f32_16x16x32_bf16 v[136:139], v[44:47], v[72:75], v[136:139]
    s_add_u32 s14, s12, 8448
    v_cvt_pk_bf16_f32 v84, v226, v227
    v_mfma_f32_16x16x32_bf16 v[140:143], v[40:43], v[60:63], v[140:143]
    v_cvt_pk_bf16_f32 v85, v230, v231
    buffer_store_dwordx2 v[84:85], v3, s[24:27], s14 offen offset:0 sc1
    v_mfma_f32_16x16x32_bf16 v[140:143], v[44:47], v[76:79], v[140:143]
    v_cvt_pk_bf16_f32 v86, v234, v235
    v_cvt_pk_bf16_f32 v87, v238, v239
    s_waitcnt lgkmcnt(0)
    v_mfma_f32_16x16x32_bf16 v[144:147], v[32:35], v[48:51], v[144:147]
    ds_read_b64_tr_b16 v[40:41], v8 offset:19456
    buffer_store_dwordx2 v[86:87], v3, s[24:27], s14 offen offset:128 sc1
    s_add_u32 s13, s12, 67584
    v_mfma_f32_16x16x32_bf16 v[144:147], v[36:39], v[64:67], v[144:147]
    v_cvt_pk_bf16_f32 v80, v240, v241
    v_cvt_pk_bf16_f32 v81, v244, v245
    v_mfma_f32_16x16x32_bf16 v[148:151], v[32:35], v[52:55], v[148:151]
    ds_read_b64_tr_b16 v[42:43], v8 offset:20608
    buffer_store_dwordx2 v[80:81], v3, s[24:27], s13 offen offset:0 sc1
    v_cvt_pk_bf16_f32 v82, v248, v249
    v_mfma_f32_16x16x32_bf16 v[148:151], v[36:39], v[68:71], v[148:151]
    v_cvt_pk_bf16_f32 v83, v252, v253
    buffer_store_dwordx2 v[82:83], v3, s[24:27], s13 offen offset:128 sc1
    v_mfma_f32_16x16x32_bf16 v[152:155], v[32:35], v[56:59], v[152:155]
    ds_read_b64_tr_b16 v[44:45], v8 offset:29184
    s_add_u32 s14, s12, 76032
    v_mfma_f32_16x16x32_bf16 v[152:155], v[36:39], v[72:75], v[152:155]
    v_cvt_pk_bf16_f32 v84, v242, v243
    v_cvt_pk_bf16_f32 v85, v246, v247
    buffer_store_dwordx2 v[84:85], v3, s[24:27], s14 offen offset:0 sc1
    v_mfma_f32_16x16x32_bf16 v[156:159], v[32:35], v[60:63], v[156:159]
    ds_read_b64_tr_b16 v[46:47], v8 offset:30336
    v_cvt_pk_bf16_f32 v86, v250, v251
    v_mfma_f32_16x16x32_bf16 v[156:159], v[36:39], v[76:79], v[156:159]
    v_cvt_pk_bf16_f32 v87, v254, v255
    buffer_store_dwordx2 v[86:87], v3, s[24:27], s14 offen offset:128 sc1
    s_waitcnt lgkmcnt(2)
    v_mfma_f32_16x16x32_bf16 v[96:99], v[40:43], v[64:67], v[96:99]
    ds_read_b64_tr_b16 v[32:33], v8 offset:64
    v_mfma_f32_16x16x32_bf16 v[100:103], v[40:43], v[68:71], v[100:103]
    ds_read_b64_tr_b16 v[34:35], v8 offset:1216
    v_mfma_f32_16x16x32_bf16 v[104:107], v[40:43], v[72:75], v[104:107]
    ds_read_b64_tr_b16 v[36:37], v8 offset:19520
    v_mfma_f32_16x16x32_bf16 v[108:111], v[40:43], v[76:79], v[108:111]
    ds_read_b64_tr_b16 v[38:39], v8 offset:20672
    s_waitcnt lgkmcnt(4)
    v_mfma_f32_16x16x32_bf16 v[112:115], v[44:47], v[64:67], v[112:115]
    ds_read_b64_tr_b16 v[40:41], v8 offset:9792
    v_mfma_f32_16x16x32_bf16 v[116:119], v[44:47], v[68:71], v[116:119]
    v_mfma_f32_16x16x32_bf16 v[120:123], v[44:47], v[72:75], v[120:123]
    ds_read_b64_tr_b16 v[42:43], v8 offset:10944
    v_mfma_f32_16x16x32_bf16 v[124:127], v[44:47], v[76:79], v[124:127]
    s_waitcnt lgkmcnt(2)
    v_mfma_f32_16x16x32_bf16 v[160:163], v[32:35], v[48:51], v[160:163]
    ds_read_b64_tr_b16 v[44:45], v8 offset:29248
    ds_read_b64_tr_b16 v[46:47], v8 offset:30400
    s_nop 3
    v_mfma_f32_16x16x32_bf16 v[160:163], v[36:39], v[64:67], v[160:163]
    v_max_f32 v96, 0, v96
    v_max_f32 v97, 0, v97
    v_mfma_f32_16x16x32_bf16 v[164:167], v[32:35], v[52:55], v[164:167]
    v_max_f32 v98, 0, v98
    v_max_f32 v99, 0, v99
    v_pk_mul_f32 v[96:97], v[96:97], v[112:113]
    v_mfma_f32_16x16x32_bf16 v[164:167], v[36:39], v[68:71], v[164:167]
    v_pk_mul_f32 v[98:99], v[98:99], v[114:115]
    v_max_f32 v128, 0, v128
    v_mfma_f32_16x16x32_bf16 v[168:171], v[32:35], v[56:59], v[168:171]
    v_max_f32 v129, 0, v129
    v_max_f32 v130, 0, v130
    v_mfma_f32_16x16x32_bf16 v[168:171], v[36:39], v[72:75], v[168:171]
    v_max_f32 v131, 0, v131
    v_pk_mul_f32 v[128:129], v[128:129], v[144:145]
    v_pk_mul_f32 v[130:131], v[130:131], v[146:147]
    v_mfma_f32_16x16x32_bf16 v[172:175], v[32:35], v[60:63], v[172:175]
    v_cvt_pk_bf16_f32 v112, v96, v97
    v_cvt_pk_bf16_f32 v113, v98, v99
    v_mfma_f32_16x16x32_bf16 v[172:175], v[36:39], v[76:79], v[172:175]
    v_cvt_pk_bf16_f32 v114, v128, v129
    v_cvt_pk_bf16_f32 v115, v130, v131
    s_waitcnt lgkmcnt(0)
    v_mfma_f32_16x16x32_bf16 v[176:179], v[40:43], v[48:51], v[176:179]
    ds_read_b64_tr_b16 v[32:33], v8 offset:96
    buffer_store_dwordx4 v[112:115], v2, s[24:27], s4 offen offset:0 sc1
    v_max_f32 v100, 0, v100
    v_mfma_f32_16x16x32_bf16 v[176:179], v[44:47], v[64:67], v[176:179]
    v_max_f32 v101, 0, v101
    v_max_f32 v102, 0, v102
    v_max_f32 v103, 0, v103
    v_mfma_f32_16x16x32_bf16 v[180:183], v[40:43], v[52:55], v[180:183]
    ds_read_b64_tr_b16 v[34:35], v8 offset:1248
    v_pk_mul_f32 v[100:101], v[100:101], v[116:117]
    v_mfma_f32_16x16x32_bf16 v[180:183], v[44:47], v[68:71], v[180:183]
    v_pk_mul_f32 v[102:103], v[102:103], v[118:119]
    v_max_f32 v132, 0, v132
    v_max_f32 v133, 0, v133
    v_mfma_f32_16x16x32_bf16 v[184:187], v[40:43], v[56:59], v[184:187]
    ds_read_b64_tr_b16 v[36:37], v8 offset:19552
    v_max_f32 v134, 0, v134
    v_max_f32 v135, 0, v135
    v_mfma_f32_16x16x32_bf16 v[184:187], v[44:47], v[72:75], v[184:187]
    v_pk_mul_f32 v[132:133], v[132:133], v[148:149]
    v_pk_mul_f32 v[134:135], v[134:135], v[150:151]
    v_mfma_f32_16x16x32_bf16 v[188:191], v[40:43], v[60:63], v[188:191]
    ds_read_b64_tr_b16 v[38:39], v8 offset:20704
    v_cvt_pk_bf16_f32 v116, v100, v101
    v_cvt_pk_bf16_f32 v117, v102, v103
    v_mfma_f32_16x16x32_bf16 v[188:191], v[44:47], v[76:79], v[188:191]
    v_cvt_pk_bf16_f32 v118, v132, v133
    v_cvt_pk_bf16_f32 v119, v134, v135
    s_waitcnt lgkmcnt(0)
    v_mfma_f32_16x16x32_bf16 v[192:195], v[32:35], v[48:51], v[192:195]
    ds_read_b64_tr_b16 v[40:41], v8 offset:9824
    s_mov_b32 s58, 65536
K1_TAG1:
    v_readfirstlane_b32 s62, v31
    s_cmp_lg_u32 s62, 0
    s_cbranch_scc1 K1_TAG1_OK
    s_sleep 8
    v_mov_b32 v31, 0
    buffer_load_dword v31, v31, s[76:79], 0 offen sc1
    s_waitcnt vmcnt(0)
    s_sub_u32 s58, s58, 1
    s_cmp_lg_u32 s58, 0
    s_cbranch_scc1 K1_TAG1
K1_TAG1_OK:
    s_waitcnt vmcnt(1)
    v_mov_b32 v20, s62
    v_mov_b32 v21, 0
    s_mov_b64 exec, 1
    buffer_store_dword v20, v21, s[24:27], s63 offen sc1
    s_mov_b64 exec, -1
    s_add_u32 s63, s63, 8192
    v_mfma_f32_16x16x32_bf16 v[192:195], v[36:39], v[64:67], v[192:195]
    buffer_store_dwordx4 v[116:119], v2, s[24:27], s5 offen offset:0 sc1
    v_max_f32 v104, 0, v104
    v_max_f32 v105, 0, v105
    v_mfma_f32_16x16x32_bf16 v[196:199], v[32:35], v[52:55], v[196:199]
    ds_read_b64_tr_b16 v[42:43], v8 offset:10976
    v_max_f32 v106, 0, v106
    v_max_f32 v107, 0, v107
    v_mfma_f32_16x16x32_bf16 v[196:199], v[36:39], v[68:71], v[196:199]
    v_pk_mul_f32 v[104:105], v[104:105], v[120:121]
    v_pk_mul_f32 v[106:107], v[106:107], v[122:123]
    v_max_f32 v136, 0, v136
    v_mfma_f32_16x16x32_bf16 v[200:203], v[32:35], v[56:59], v[200:203]
    ds_read_b64_tr_b16 v[44:45], v8 offset:29280
    v_max_f32 v137, 0, v137
    v_max_f32 v138, 0, v138
    v_mfma_f32_16x16x32_bf16 v[200:203], v[36:39], v[72:75], v[200:203]
    v_max_f32 v139, 0, v139
    v_pk_mul_f32 v[136:137], v[136:137], v[152:153]
    v_pk_mul_f32 v[138:139], v[138:139], v[154:155]
    v_mfma_f32_16x16x32_bf16 v[204:207], v[32:35], v[60:63], v[204:207]
    ds_read_b64_tr_b16 v[46:47], v8 offset:30432
    v_cvt_pk_bf16_f32 v120, v104, v105
    v_cvt_pk_bf16_f32 v121, v106, v107
    v_mfma_f32_16x16x32_bf16 v[204:207], v[36:39], v[76:79], v[204:207]
    v_cvt_pk_bf16_f32 v122, v136, v137
    v_cvt_pk_bf16_f32 v123, v138, v139
    s_waitcnt lgkmcnt(0)
    v_mfma_f32_16x16x32_bf16 v[208:211], v[40:43], v[48:51], v[208:211]
    buffer_store_dwordx4 v[120:123], v2, s[24:27], s6 offen offset:0 sc1
    v_max_f32 v108, 0, v108
    v_max_f32 v109, 0, v109
    v_mfma_f32_16x16x32_bf16 v[208:211], v[44:47], v[64:67], v[208:211]
    v_max_f32 v110, 0, v110
    v_max_f32 v111, 0, v111
    v_mfma_f32_16x16x32_bf16 v[212:215], v[40:43], v[52:55], v[212:215]
    v_pk_mul_f32 v[108:109], v[108:109], v[124:125]
    v_pk_mul_f32 v[110:111], v[110:111], v[126:127]
    v_mfma_f32_16x16x32_bf16 v[212:215], v[44:47], v[68:71], v[212:215]
    v_max_f32 v140, 0, v140
    v_max_f32 v141, 0, v141
    v_mfma_f32_16x16x32_bf16 v[216:219], v[40:43], v[56:59], v[216:219]
    v_max_f32 v142, 0, v142
    v_max_f32 v143, 0, v143
    v_pk_mul_f32 v[140:141], v[140:141], v[156:157]
    v_mfma_f32_16x16x32_bf16 v[216:219], v[44:47], v[72:75], v[216:219]
    v_pk_mul_f32 v[142:143], v[142:143], v[158:159]
    v_cvt_pk_bf16_f32 v124, v108, v109
    v_mfma_f32_16x16x32_bf16 v[220:223], v[40:43], v[60:63], v[220:223]
    v_cvt_pk_bf16_f32 v125, v110, v111
    v_cvt_pk_bf16_f32 v126, v140, v141
    v_mfma_f32_16x16x32_bf16 v[220:223], v[44:47], v[76:79], v[220:223]
    v_cvt_pk_bf16_f32 v127, v142, v143
    buffer_store_dwordx4 v[124:127], v2, s[24:27], s7 offen offset:0 sc1
    s_waitcnt vmcnt(0)
    v_mov_b32 v20, s62
    v_mov_b32 v21, 0
    s_mov_b64 exec, 1
    buffer_store_dword v20, v21, s[24:27], s63 offen sc1
    s_mov_b64 exec, -1
    s_add_u32 s63, s63, 8192
    s_barrier
    s_nop 6
    v_max_f32 v160, 0, v160
    v_max_f32 v161, 0, v161
    v_max_f32 v162, 0, v162
    v_max_f32 v163, 0, v163
    v_pk_mul_f32 v[160:161], v[160:161], v[176:177]
    v_pk_mul_f32 v[162:163], v[162:163], v[178:179]
    v_max_f32 v192, 0, v192
    v_max_f32 v193, 0, v193
    v_max_f32 v194, 0, v194
    v_max_f32 v195, 0, v195
    v_pk_mul_f32 v[192:193], v[192:193], v[208:209]
    v_pk_mul_f32 v[194:195], v[194:195], v[210:211]
    v_cvt_pk_bf16_f32 v176, v160, v161
    v_cvt_pk_bf16_f32 v177, v162, v163
    v_cvt_pk_bf16_f32 v178, v192, v193
    v_cvt_pk_bf16_f32 v179, v194, v195
    v_max_f32 v164, 0, v164
    v_max_f32 v165, 0, v165
    v_max_f32 v166, 0, v166
    v_max_f32 v167, 0, v167
    v_pk_mul_f32 v[164:165], v[164:165], v[180:181]
    v_pk_mul_f32 v[166:167], v[166:167], v[182:183]
    v_max_f32 v196, 0, v196
    v_max_f32 v197, 0, v197
    v_max_f32 v198, 0, v198
    v_max_f32 v199, 0, v199
    v_pk_mul_f32 v[196:197], v[196:197], v[212:213]
    v_pk_mul_f32 v[198:199], v[198:199], v[214:215]
    v_cvt_pk_bf16_f32 v180, v164, v165
    v_cvt_pk_bf16_f32 v181, v166, v167
    v_cvt_pk_bf16_f32 v182, v196, v197
    v_cvt_pk_bf16_f32 v183, v198, v199
    v_max_f32 v168, 0, v168
    v_max_f32 v169, 0, v169
    v_max_f32 v170, 0, v170
    v_max_f32 v171, 0, v171
    v_pk_mul_f32 v[168:169], v[168:169], v[184:185]
    v_pk_mul_f32 v[170:171], v[170:171], v[186:187]
    v_max_f32 v200, 0, v200
    v_max_f32 v201, 0, v201
    v_max_f32 v202, 0, v202
    v_max_f32 v203, 0, v203
    v_pk_mul_f32 v[200:201], v[200:201], v[216:217]
    v_pk_mul_f32 v[202:203], v[202:203], v[218:219]
    v_cvt_pk_bf16_f32 v184, v168, v169
    v_cvt_pk_bf16_f32 v185, v170, v171
    v_cvt_pk_bf16_f32 v186, v200, v201
    v_cvt_pk_bf16_f32 v187, v202, v203
    v_max_f32 v172, 0, v172
    v_max_f32 v173, 0, v173
    v_max_f32 v174, 0, v174
    v_max_f32 v175, 0, v175
    v_pk_mul_f32 v[172:173], v[172:173], v[188:189]
    v_pk_mul_f32 v[174:175], v[174:175], v[190:191]
    v_max_f32 v204, 0, v204
    v_max_f32 v205, 0, v205
    v_max_f32 v206, 0, v206
    v_max_f32 v207, 0, v207
    v_pk_mul_f32 v[204:205], v[204:205], v[220:221]
    v_pk_mul_f32 v[206:207], v[206:207], v[222:223]
    v_cvt_pk_bf16_f32 v188, v172, v173
    v_cvt_pk_bf16_f32 v189, v174, v175
    v_cvt_pk_bf16_f32 v190, v204, v205
    v_cvt_pk_bf16_f32 v191, v206, v207
    s_branch K1_FIN
K1_P0:
    ds_read_b128 v[48:51], v88 offset:0
    ds_read_b128 v[52:55], v88 offset:2048
    ds_read_b128 v[56:59], v88 offset:4096
    ds_read_b128 v[60:63], v88 offset:6144
    ds_read_b64_tr_b16 v[32:33], v8 offset:0
    ds_read_b64_tr_b16 v[34:35], v8 offset:1152
    ds_read_b64_tr_b16 v[36:37], v8 offset:9728
    ds_read_b64_tr_b16 v[38:39], v8 offset:10880
K1_L0:
    s_waitcnt lgkmcnt(2)
    v_mfma_f32_16x16x32_bf16 v[96:99], v[32:35], v[48:51], v[96:99]
    ds_read_b128 v[64:67], v89 offset:0
    ds_read_b128 v[68:71], v89 offset:2048
    v_mfma_f32_16x16x32_bf16 v[100:103], v[32:35], v[52:55], v[100:103]
    ds_read_b64_tr_b16 v[40:41], v8 offset:32
    ds_read_b64_tr_b16 v[42:43], v8 offset:1184
    v_mfma_f32_16x16x32_bf16 v[104:107], v[32:35], v[56:59], v[104:107]
    ds_read_b64_tr_b16 v[44:45], v8 offset:9760
    ds_read_b64_tr_b16 v[46:47], v8 offset:10912
    v_mfma_f32_16x16x32_bf16 v[108:111], v[32:35], v[60:63], v[108:111]
    s_add_u32 m0, s44, 2048
    s_nop 0
    buffer_load_dwordx4 v2, s[16:19], s42 offen lds
    s_waitcnt lgkmcnt(6)
    v_mfma_f32_16x16x32_bf16 v[112:115], v[36:39], v[48:51], v[112:115]
    ds_read_b128 v[72:75], v89 offset:4096
    ds_read_b128 v[76:79], v89 offset:6144
    v_mfma_f32_16x16x32_bf16 v[116:119], v[36:39], v[52:55], v[116:119]
    v_xor_b32 v88, 32768, v88
    v_xor_b32 v89, 32768, v89
    v_mfma_f32_16x16x32_bf16 v[120:123], v[36:39], v[56:59], v[120:123]
    ds_read_b64_tr_b16 v[32:33], v8 offset:29216
    ds_read_b64_tr_b16 v[34:35], v8 offset:30368
    v_mfma_f32_16x16x32_bf16 v[124:127], v[36:39], v[60:63], v[124:127]
    s_add_u32 m0, s44, 3072
    s_nop 0
    buffer_load_dwordx4 v3, s[16:19], s42 offen lds
    s_add_u32 s41, s41, 128
    s_xor_b32 s44, s44, 32768
    s_cmp_ge_u32 s41, 1152
    s_cselect_b32 s41, 0x40000000, s41
    s_add_u32 s42, s41, 1179648
    s_waitcnt lgkmcnt(6)
    v_mfma_f32_16x16x32_bf16 v[128:131], v[40:43], v[48:51], v[128:131]
    ds_read_b64_tr_b16 v[36:37], v8 offset:64
    v_mfma_f32_16x16x32_bf16 v[132:135], v[40:43], v[52:55], v[132:135]
    ds_read_b64_tr_b16 v[38:39], v8 offset:1216
    v_mfma_f32_16x16x32_bf16 v[136:139], v[40:43], v[56:59], v[136:139]
    s_add_u32 m0, s45, 0
    s_nop 0
    buffer_load_dwordx4 v4, s[20:23], s43 offen lds
    v_mfma_f32_16x16x32_bf16 v[140:143], v[40:43], v[60:63], v[140:143]
    s_waitcnt lgkmcnt(2)
    v_mfma_f32_16x16x32_bf16 v[144:147], v[44:47], v[48:51], v[144:147]
    ds_read_b64_tr_b16 v[40:41], v8 offset:19520
    v_mfma_f32_16x16x32_bf16 v[144:147], v[32:35], v[64:67], v[144:147]
    v_mfma_f32_16x16x32_bf16 v[148:151], v[44:47], v[52:55], v[148:151]
    ds_read_b64_tr_b16 v[42:43], v8 offset:20672
    v_mfma_f32_16x16x32_bf16 v[148:151], v[32:35], v[68:71], v[148:151]
    v_mfma_f32_16x16x32_bf16 v[152:155], v[44:47], v[56:59], v[152:155]
    s_add_u32 m0, s45, 1024
    s_nop 0
    buffer_load_dwordx4 v5, s[20:23], s43 offen lds
    v_mfma_f32_16x16x32_bf16 v[152:155], v[32:35], v[72:75], v[152:155]
    v_mfma_f32_16x16x32_bf16 v[156:159], v[44:47], v[60:63], v[156:159]
    s_add_u32 m0, s45, 2048
    s_mov_b64 exec, 0xffff
    buffer_load_dwordx4 v6, s[20:23], s43 offen lds
    s_mov_b64 exec, -1
    s_add_u32 s43, s43, 294912
    s_add_u32 s45, s45, 19456
    s_cmp_ge_u32 s45, 143360
    s_cselect_b32 s52, 77824, 0
    s_sub_u32 s45, s45, s52
    v_mfma_f32_16x16x32_bf16 v[156:159], v[32:35], v[76:79], v[156:159]
    s_waitcnt lgkmcnt(0)
    v_mfma_f32_16x16x32_bf16 v[160:163], v[36:39], v[48:51], v[160:163]
    ds_read_b64_tr_b16 v[44:45], v8 offset:9792
    v_mfma_f32_16x16x32_bf16 v[160:163], v[40:43], v[64:67], v[160:163]
    ds_read_b64_tr_b16 v[46:47], v8 offset:10944
    v_mfma_f32_16x16x32_bf16 v[164:167], v[36:39], v[52:55], v[164:167]
    ds_read_b64_tr_b16 v[32:33], v8 offset:29248
    v_mfma_f32_16x16x32_bf16 v[164:167], v[40:43], v[68:71], v[164:167]
    v_mfma_f32_16x16x32_bf16 v[168:171], v[36:39], v[56:59], v[168:171]
    ds_read_b64_tr_b16 v[34:35], v8 offset:30400
    v_mfma_f32_16x16x32_bf16 v[168:171], v[40:43], v[72:75], v[168:171]
    s_add_u32 m0, s45, 0
    s_nop 0
    buffer_load_dwordx4 v4, s[20:23], s43 offen lds
    v_mfma_f32_16x16x32_bf16 v[172:175], v[36:39], v[60:63], v[172:175]
    s_add_u32 m0, s45, 1024
    s_nop 0
    buffer_load_dwordx4 v5, s[20:23], s43 offen lds
    v_mfma_f32_16x16x32_bf16 v[172:175], v[40:43], v[76:79], v[172:175]
    s_waitcnt lgkmcnt(0)
    v_mfma_f32_16x16x32_bf16 v[176:179], v[44:47], v[48:51], v[176:179]
    ds_read_b64_tr_b16 v[36:37], v8 offset:96
    v_mfma_f32_16x16x32_bf16 v[176:179], v[32:35], v[64:67], v[176:179]
    ds_read_b64_tr_b16 v[38:39], v8 offset:1248
    v_mfma_f32_16x16x32_bf16 v[180:183], v[44:47], v[52:55], v[180:183]
    v_mfma_f32_16x16x32_bf16 v[180:183], v[32:35], v[68:71], v[180:183]
    ds_read_b64_tr_b16 v[40:41], v8 offset:19552
    v_mfma_f32_16x16x32_bf16 v[184:187], v[44:47], v[56:59], v[184:187]
    ds_read_b64_tr_b16 v[42:43], v8 offset:20704
    v_mfma_f32_16x16x32_bf16 v[184:187], v[32:35], v[72:75], v[184:187]
    v_mfma_f32_16x16x32_bf16 v[188:191], v[44:47], v[60:63], v[188:191]
    s_add_u32 m0, s45, 2048
    s_mov_b64 exec, 0xffff
    buffer_load_dwordx4 v6, s[20:23], s43 offen lds
    s_mov_b64 exec, -1
    s_add_u32 s43, s43, 294912
    s_add_u32 s45, s45, 19456
    s_cmp_ge_u32 s45, 143360
    s_cselect_b32 s52, 77824, 0
    s_sub_u32 s45, s45, s52
    v_mfma_f32_16x16x32_bf16 v[188:191], v[32:35], v[76:79], v[188:191]
    s_waitcnt lgkmcnt(0)
    v_mfma_f32_16x16x32_bf16 v[192:195], v[36:39], v[48:51], v[192:195]
    ds_read_b64_tr_b16 v[44:45], v8 offset:9824
    v_mfma_f32_16x16x32_bf16 v[192:195], v[40:43], v[64:67], v[192:195]
    ds_read_b64_tr_b16 v[46:47], v8 offset:10976
    v_mfma_f32_16x16x32_bf16 v[196:199], v[36:39], v[52:55], v[196:199]
    v_mfma_f32_16x16x32_bf16 v[196:199], v[40:43], v[68:71], v[196:199]
    ds_read_b64_tr_b16 v[32:33], v8 offset:29280
    v_mfma_f32_16x16x32_bf16 v[200:203], v[36:39], v[56:59], v[200:203]
    ds_read_b64_tr_b16 v[34:35], v8 offset:30432
    v_mfma_f32_16x16x32_bf16 v[200:203], v[40:43], v[72:75], v[200:203]
    v_mfma_f32_16x16x32_bf16 v[204:207], v[36:39], v[60:63], v[204:207]
    s_cmp_lg_u32 s47, s33
    s_cbranch_scc1 K1_S0_w
    s_mov_b32 exec_hi, 0x3fffff
    buffer_load_dword v94, v91, s[20:23], 0 offen
    s_mov_b32 exec_hi, -1
    s_branch K1_SE0
K1_S0_w:
    s_cmp_lg_u32 s47, 5
    s_cbranch_scc1 K1_S0_0
    s_mov_b32 m0, s60
    s_nop 0
    buffer_load_dwordx4 v29, s[28:31], s61 offen lds
    s_branch K1_SE0
K1_S0_0:
    s_cmp_lg_u32 s47, 4
    s_cbranch_scc1 K1_S0_1
    s_add_u32 m0, s60, 1024
    s_mov_b64 exec, 0xffff
    buffer_load_dwordx4 v30, s[28:31], s61 offen lds
    s_mov_b64 exec, -1
    s_branch K1_SE0
K1_S0_1:
    s_cmp_lg_u32 s47, 3
    s_cbranch_scc1 K1_S0_2
    s_mov_b64 exec, 0x1fffff
    buffer_load_dword v94, v90, s[96:99], s3 offen
    s_mov_b64 exec, -1
    s_branch K1_SE0
K1_S0_2:
    s_cmp_lg_u32 s47, 2
    s_cbranch_scc1 K1_S0_3
    v_mov_b32 v31, 0
    buffer_load_dword v31, v31, s[76:79], 0 offen sc1
    s_branch K1_SE0
K1_S0_3:
    s_cmp_lg_u32 s47, 1
    s_cbranch_scc1 K1_S0_4
    v_add_u32 v90, 540672, v11
    v_mov_b32 v91, 0x40000000
    v_cmp_gt_u32 vcc, s15, v0
    s_nop 1
    v_cndmask_b32 v90, v91, v90, vcc
    ds_read_u16 v80, v18 offset:0
    ds_read_u16 v84, v18 offset:5120
    ds_read_u16 v81, v18 offset:1280
    ds_read_u16 v85, v18 offset:6400
    ds_read_u16 v82, v18 offset:2560
    ds_read_u16 v86, v18 offset:7680
    ds_read_u16 v83, v18 offset:3840
    ds_read_u16 v87, v18 offset:8960
    s_waitcnt lgkmcnt(0)
    v_lshl_or_b32 v92, v84, 16, v80
    v_lshl_or_b32 v93, v85, 16, v81
    v_lshl_or_b32 v94, v86, 16, v82
    v_lshl_or_b32 v95, v87, 16, v83
    buffer_store_dwordx4 v[92:95], v11, s[24:27], s48 offen sc1
    ds_read_u16 v80, v18 offset:128
    ds_read_u16 v84, v18 offset:5248
    ds_read_u16 v81, v18 offset:1408
    ds_read_u16 v85, v18 offset:6528
    ds_read_u16 v82, v18 offset:2688
    ds_read_u16 v86, v18 offset:7808
    ds_read_u16 v83, v18 offset:3968
    ds_read_u16 v87, v18 offset:9088
    s_waitcnt lgkmcnt(0)
    v_lshl_or_b32 v92, v84, 16, v80
    v_lshl_or_b32 v93, v85, 16, v81
    v_lshl_or_b32 v94, v86, 16, v82
    v_lshl_or_b32 v95, v87, 16, v83
    buffer_store_dwordx4 v[92:95], v90, s[24:27], s48 offen sc1
    s_branch K1_SE0
K1_S0_4:
    buffer_load_dword v95, v19, s[76:79], 0 offen
K1_SE0:
    v_mfma_f32_16x16x32_bf16 v[204:207], v[40:43], v[76:79], v[204:207]
    s_waitcnt lgkmcnt(0)
    v_mfma_f32_16x16x32_bf16 v[208:211], v[44:47], v[48:51], v[208:211]
    ds_read_b64_tr_b16 v[36:37], v10 offset:0
    v_mfma_f32_16x16x32_bf16 v[208:211], v[32:35], v[64:67], v[208:211]
    v_mfma_f32_16x16x32_bf16 v[212:215], v[44:47], v[52:55], v[212:215]
    ds_read_b64_tr_b16 v[38:39], v10 offset:1152
    v_mfma_f32_16x16x32_bf16 v[212:215], v[32:35], v[68:71], v[212:215]
    v_mfma_f32_16x16x32_bf16 v[216:219], v[44:47], v[56:59], v[216:219]
    ds_read_b64_tr_b16 v[40:41], v10 offset:19456
    v_mfma_f32_16x16x32_bf16 v[216:219], v[32:35], v[72:75], v[216:219]
    v_mfma_f32_16x16x32_bf16 v[220:223], v[44:47], v[60:63], v[220:223]
    ds_read_b64_tr_b16 v[42:43], v10 offset:20608
    v_mfma_f32_16x16x32_bf16 v[220:223], v[32:35], v[76:79], v[220:223]
    s_waitcnt lgkmcnt(0)
    v_mfma_f32_16x16x32_bf16 v[224:227], v[36:39], v[48:51], v[224:227]
    ds_read_b64_tr_b16 v[44:45], v10 offset:9728
    v_mfma_f32_16x16x32_bf16 v[224:227], v[40:43], v[64:67], v[224:227]
    v_mfma_f32_16x16x32_bf16 v[228:231], v[36:39], v[52:55], v[228:231]
    ds_read_b64_tr_b16 v[46:47], v10 offset:10880
    v_mfma_f32_16x16x32_bf16 v[228:231], v[40:43], v[68:71], v[228:231]
    v_mfma_f32_16x16x32_bf16 v[232:235], v[36:39], v[56:59], v[232:235]
    ds_read_b64_tr_b16 v[32:33], v10 offset:29184
    v_mfma_f32_16x16x32_bf16 v[232:235], v[40:43], v[72:75], v[232:235]
    v_mfma_f32_16x16x32_bf16 v[236:239], v[36:39], v[60:63], v[236:239]
    ds_read_b64_tr_b16 v[34:35], v10 offset:30336
    v_mfma_f32_16x16x32_bf16 v[236:239], v[40:43], v[76:79], v[236:239]
    s_waitcnt lgkmcnt(0)
    v_mfma_f32_16x16x32_bf16 v[240:243], v[44:47], v[48:51], v[240:243]
    ds_read_b64_tr_b16 v[36:37], v8 offset:19456
    v_mfma_f32_16x16x32_bf16 v[240:243], v[32:35], v[64:67], v[240:243]
    v_mfma_f32_16x16x32_bf16 v[244:247], v[44:47], v[52:55], v[244:247]
    ds_read_b64_tr_b16 v[38:39], v8 offset:20608
    v_mfma_f32_16x16x32_bf16 v[244:247], v[32:35], v[68:71], v[244:247]
    v_mfma_f32_16x16x32_bf16 v[248:251], v[44:47], v[56:59], v[248:251]
    ds_read_b64_tr_b16 v[40:41], v8 offset:29184
    v_mfma_f32_16x16x32_bf16 v[248:251], v[32:35], v[72:75], v[248:251]
    v_mfma_f32_16x16x32_bf16 v[252:255], v[44:47], v[60:63], v[252:255]
    ds_read_b64_tr_b16 v[42:43], v8 offset:30336
    v_mfma_f32_16x16x32_bf16 v[252:255], v[32:35], v[76:79], v[252:255]
    s_waitcnt lgkmcnt(2)
    v_mfma_f32_16x16x32_bf16 v[96:99], v[36:39], v[64:67], v[96:99]
    ds_read_b64_tr_b16 v[44:45], v8 offset:19488
    v_mfma_f32_16x16x32_bf16 v[100:103], v[36:39], v[68:71], v[100:103]
    ds_read_b64_tr_b16 v[46:47], v8 offset:20640
    v_mfma_f32_16x16x32_bf16 v[104:107], v[36:39], v[72:75], v[104:107]
    s_xor_b32 s46, s46, 0x9800
    v_add_u32 v8, s46, v7
    v_mfma_f32_16x16x32_bf16 v[108:111], v[36:39], v[76:79], v[108:111]
    v_add_u32 v10, s46, v9
    s_waitcnt vmcnt(1) lgkmcnt(0)
    s_barrier
    v_mfma_f32_16x16x32_bf16 v[112:115], v[40:43], v[64:67], v[112:115]
    ds_read_b128 v[48:51], v88 offset:0
    ds_read_b128 v[52:55], v88 offset:2048
    ds_read_b128 v[56:59], v88 offset:4096
    v_mfma_f32_16x16x32_bf16 v[116:119], v[40:43], v[68:71], v[116:119]
    ds_read_b128 v[60:63], v88 offset:6144
    ds_read_b64_tr_b16 v[32:33], v8 offset:0
    v_mfma_f32_16x16x32_bf16 v[120:123], v[40:43], v[72:75], v[120:123]
    ds_read_b64_tr_b16 v[34:35], v8 offset:1152
    ds_read_b64_tr_b16 v[36:37], v8 offset:9728
    v_mfma_f32_16x16x32_bf16 v[124:127], v[40:43], v[76:79], v[124:127]
    ds_read_b64_tr_b16 v[38:39], v8 offset:10880
    s_add_u32 m0, s44, 0
    s_nop 0
    buffer_load_dwordx4 v2, s[16:19], s41 offen lds
    v_mfma_f32_16x16x32_bf16 v[128:131], v[44:47], v[64:67], v[128:131]
    s_add_u32 m0, s44, 1024
    s_nop 0
    buffer_load_dwordx4 v3, s[16:19], s41 offen lds
    v_mfma_f32_16x16x32_bf16 v[132:135], v[44:47], v[68:71], v[132:135]
    v_mfma_f32_16x16x32_bf16 v[136:139], v[44:47], v[72:75], v[136:139]
    v_mfma_f32_16x16x32_bf16 v[140:143], v[44:47], v[76:79], v[140:143]
    s_sub_u32 s47, s47, 1
    s_cmp_lg_u32 s47, 0
    s_cbranch_scc1 K1_L0
    v_lshlrev_b32 v2, 4, v1
    s_waitcnt lgkmcnt(2)
    v_mfma_f32_16x16x32_bf16 v[96:99], v[32:35], v[48:51], v[96:99]
    ds_read_b128 v[64:67], v89 offset:0
    ds_read_b128 v[68:71], v89 offset:2048
    v_mfma_f32_16x16x32_bf16 v[100:103], v[32:35], v[52:55], v[100:103]
    ds_read_b128 v[72:75], v89 offset:4096
    ds_read_b128 v[76:79], v89 offset:6144
    v_mfma_f32_16x16x32_bf16 v[104:107], v[32:35], v[56:59], v[104:107]
    ds_read_b64_tr_b16 v[40:41], v8 offset:32
    ds_read_b64_tr_b16 v[42:43], v8 offset:1184
    v_mfma_f32_16x16x32_bf16 v[108:111], v[32:35], v[60:63], v[108:111]
    ds_read_b64_tr_b16 v[44:45], v8 offset:19488
    ds_read_b64_tr_b16 v[46:47], v8 offset:20640
    s_waitcnt lgkmcnt(8)
    v_mfma_f32_16x16x32_bf16 v[112:115], v[36:39], v[48:51], v[112:115]
    ds_read_b64_tr_b16 v[32:33], v8 offset:9760
    v_mfma_f32_16x16x32_bf16 v[116:119], v[36:39], v[52:55], v[116:119]
    v_mfma_f32_16x16x32_bf16 v[120:123], v[36:39], v[56:59], v[120:123]
    ds_read_b64_tr_b16 v[34:35], v8 offset:10912
    v_mfma_f32_16x16x32_bf16 v[124:127], v[36:39], v[60:63], v[124:127]
    s_waitcnt lgkmcnt(2)
    v_mfma_f32_16x16x32_bf16 v[128:131], v[40:43], v[48:51], v[128:131]
    ds_read_b64_tr_b16 v[36:37], v8 offset:29216
    v_mfma_f32_16x16x32_bf16 v[128:131], v[44:47], v[64:67], v[128:131]
    v_mfma_f32_16x16x32_bf16 v[132:135], v[40:43], v[52:55], v[132:135]
    v_mfma_f32_16x16x32_bf16 v[132:135], v[44:47], v[68:71], v[132:135]
    v_mfma_f32_16x16x32_bf16 v[136:139], v[40:43], v[56:59], v[136:139]
    ds_read_b64_tr_b16 v[38:39], v8 offset:30368
    v_mfma_f32_16x16x32_bf16 v[136:139], v[44:47], v[72:75], v[136:139]
    v_mfma_f32_16x16x32_bf16 v[140:143], v[40:43], v[60:63], v[140:143]
    v_mfma_f32_16x16x32_bf16 v[140:143], v[44:47], v[76:79], v[140:143]
    s_waitcnt lgkmcnt(0)
    v_mfma_f32_16x16x32_bf16 v[144:147], v[32:35], v[48:51], v[144:147]
    ds_read_b64_tr_b16 v[40:41], v8 offset:19456
    v_mfma_f32_16x16x32_bf16 v[144:147], v[36:39], v[64:67], v[144:147]
    s_mov_b32 s58, 65536
K1_TAG0:
    v_readfirstlane_b32 s62, v31
    s_cmp_lg_u32 s62, 0
    s_cbranch_scc1 K1_TAG0_OK
    s_sleep 8
    v_mov_b32 v31, 0
    buffer_load_dword v31, v31, s[76:79], 0 offen sc1
    s_waitcnt vmcnt(0)
    s_sub_u32 s58, s58, 1
    s_cmp_lg_u32 s58, 0
    s_cbranch_scc1 K1_TAG0
K1_TAG0_OK:
    v_mfma_f32_16x16x32_bf16 v[148:151], v[32:35], v[52:55], v[148:151]
    ds_read_b64_tr_b16 v[42:43], v8 offset:20608
    v_mfma_f32_16x16x32_bf16 v[148:151], v[36:39], v[68:71], v[148:151]
    v_mfma_f32_16x16x32_bf16 v[152:155], v[32:35], v[56:59], v[152:155]
    ds_read_b64_tr_b16 v[44:45], v8 offset:29184
    v_mfma_f32_16x16x32_bf16 v[152:155], v[36:39], v[72:75], v[152:155]
    s_waitcnt vmcnt(0)
    v_mov_b32 v20, s62
    v_mov_b32 v21, 0
    s_mov_b64 exec, 1
    buffer_store_dword v20, v21, s[24:27], s63 offen sc1
    s_mov_b64 exec, -1
    s_add_u32 s63, s63, 8192
    v_mfma_f32_16x16x32_bf16 v[156:159], v[32:35], v[60:63], v[156:159]
    ds_read_b64_tr_b16 v[46:47], v8 offset:30336
    v_mfma_f32_16x16x32_bf16 v[156:159], v[36:39], v[76:79], v[156:159]
    s_waitcnt lgkmcnt(2)
    v_mfma_f32_16x16x32_bf16 v[96:99], v[40:43], v[64:67], v[96:99]
    ds_read_b64_tr_b16 v[32:33], v8 offset:64
    v_mfma_f32_16x16x32_bf16 v[100:103], v[40:43], v[68:71], v[100:103]
    ds_read_b64_tr_b16 v[34:35], v8 offset:1216
    v_mfma_f32_16x16x32_bf16 v[104:107], v[40:43], v[72:75], v[104:107]
    ds_read_b64_tr_b16 v[36:37], v8 offset:19520
    v_mfma_f32_16x16x32_bf16 v[108:111], v[40:43], v[76:79], v[108:111]
    ds_read_b64_tr_b16 v[38:39], v8 offset:20672
    s_waitcnt lgkmcnt(4)
    v_mfma_f32_16x16x32_bf16 v[112:115], v[44:47], v[64:67], v[112:115]
    ds_read_b64_tr_b16 v[40:41], v8 offset:9792
    v_mfma_f32_16x16x32_bf16 v[116:119], v[44:47], v[68:71], v[116:119]
    v_mfma_f32_16x16x32_bf16 v[120:123], v[44:47], v[72:75], v[120:123]
    ds_read_b64_tr_b16 v[42:43], v8 offset:10944
    v_mfma_f32_16x16x32_bf16 v[124:127], v[44:47], v[76:79], v[124:127]
    s_waitcnt lgkmcnt(2)
    v_mfma_f32_16x16x32_bf16 v[160:163], v[32:35], v[48:51], v[160:163]
    ds_read_b64_tr_b16 v[44:45], v8 offset:29248
    ds_read_b64_tr_b16 v[46:47], v8 offset:30400
    s_nop 3
    v_mfma_f32_16x16x32_bf16 v[160:163], v[36:39], v[64:67], v[160:163]
    v_max_f32 v96, 0, v96
    v_max_f32 v97, 0, v97
    v_mfma_f32_16x16x32_bf16 v[164:167], v[32:35], v[52:55], v[164:167]
    v_max_f32 v98, 0, v98
    v_max_f32 v99, 0, v99
    v_pk_mul_f32 v[96:97], v[96:97], v[112:113]
    v_mfma_f32_16x16x32_bf16 v[164:167], v[36:39], v[68:71], v[164:167]
    v_pk_mul_f32 v[98:99], v[98:99], v[114:115]
    v_max_f32 v128, 0, v128
    v_mfma_f32_16x16x32_bf16 v[168:171], v[32:35], v[56:59], v[168:171]
    v_max_f32 v129, 0, v129
    v_max_f32 v130, 0, v130
    v_mfma_f32_16x16x32_bf16 v[168:171], v[36:39], v[72:75], v[168:171]
    v_max_f32 v131, 0, v131
    v_pk_mul_f32 v[128:129], v[128:129], v[144:145]
    v_pk_mul_f32 v[130:131], v[130:131], v[146:147]
    v_mfma_f32_16x16x32_bf16 v[172:175], v[32:35], v[60:63], v[172:175]
    v_cvt_pk_bf16_f32 v112, v96, v97
    v_cvt_pk_bf16_f32 v113, v98, v99
    v_mfma_f32_16x16x32_bf16 v[172:175], v[36:39], v[76:79], v[172:175]
    v_cvt_pk_bf16_f32 v114, v128, v129
    v_cvt_pk_bf16_f32 v115, v130, v131
    s_waitcnt lgkmcnt(0)
    v_mfma_f32_16x16x32_bf16 v[176:179], v[40:43], v[48:51], v[176:179]
    ds_read_b64_tr_b16 v[32:33], v8 offset:96
    buffer_store_dwordx4 v[112:115], v2, s[24:27], s4 offen offset:0 sc1
    v_max_f32 v100, 0, v100
    v_mfma_f32_16x16x32_bf16 v[176:179], v[44:47], v[64:67], v[176:179]
    v_max_f32 v101, 0, v101
    v_max_f32 v102, 0, v102
    v_max_f32 v103, 0, v103
    v_mfma_f32_16x16x32_bf16 v[180:183], v[40:43], v[52:55], v[180:183]
    ds_read_b64_tr_b16 v[34:35], v8 offset:1248
    v_pk_mul_f32 v[100:101], v[100:101], v[116:117]
    v_mfma_f32_16x16x32_bf16 v[180:183], v[44:47], v[68:71], v[180:183]
    v_pk_mul_f32 v[102:103], v[102:103], v[118:119]
    v_max_f32 v132, 0, v132
    v_max_f32 v133, 0, v133
    v_mfma_f32_16x16x32_bf16 v[184:187], v[40:43], v[56:59], v[184:187]
    ds_read_b64_tr_b16 v[36:37], v8 offset:19552
    v_max_f32 v134, 0, v134
    v_max_f32 v135, 0, v135
    v_mfma_f32_16x16x32_bf16 v[184:187], v[44:47], v[72:75], v[184:187]
    v_pk_mul_f32 v[132:133], v[132:133], v[148:149]
    v_pk_mul_f32 v[134:135], v[134:135], v[150:151]
    v_mfma_f32_16x16x32_bf16 v[188:191], v[40:43], v[60:63], v[188:191]
    ds_read_b64_tr_b16 v[38:39], v8 offset:20704
    v_cvt_pk_bf16_f32 v116, v100, v101
    v_cvt_pk_bf16_f32 v117, v102, v103
    v_mfma_f32_16x16x32_bf16 v[188:191], v[44:47], v[76:79], v[188:191]
    v_cvt_pk_bf16_f32 v118, v132, v133
    v_cvt_pk_bf16_f32 v119, v134, v135
    s_waitcnt lgkmcnt(0)
    v_mfma_f32_16x16x32_bf16 v[192:195], v[32:35], v[48:51], v[192:195]
    ds_read_b64_tr_b16 v[40:41], v8 offset:9824
    buffer_store_dwordx4 v[116:119], v2, s[24:27], s5 offen offset:0 sc1
    v_max_f32 v104, 0, v104
    v_mfma_f32_16x16x32_bf16 v[192:195], v[36:39], v[64:67], v[192:195]
    v_max_f32 v105, 0, v105
    v_max_f32 v106, 0, v106
    v_max_f32 v107, 0, v107
    v_mfma_f32_16x16x32_bf16 v[196:199], v[32:35], v[52:55], v[196:199]
    ds_read_b64_tr_b16 v[42:43], v8 offset:10976
    v_pk_mul_f32 v[104:105], v[104:105], v[120:121]
    v_mfma_f32_16x16x32_bf16 v[196:199], v[36:39], v[68:71], v[196:199]
    v_pk_mul_f32 v[106:107], v[106:107], v[122:123]
    v_max_f32 v136, 0, v136
    v_max_f32 v137, 0, v137
    v_mfma_f32_16x16x32_bf16 v[200:203], v[32:35], v[56:59], v[200:203]
    ds_read_b64_tr_b16 v[44:45], v8 offset:29280
    v_max_f32 v138, 0, v138
    v_max_f32 v139, 0, v139
    v_mfma_f32_16x16x32_bf16 v[200:203], v[36:39], v[72:75], v[200:203]
    v_pk_mul_f32 v[136:137], v[136:137], v[152:153]
    v_pk_mul_f32 v[138:139], v[138:139], v[154:155]
    v_mfma_f32_16x16x32_bf16 v[204:207], v[32:35], v[60:63], v[204:207]
    ds_read_b64_tr_b16 v[46:47], v8 offset:30432
    v_cvt_pk_bf16_f32 v120, v104, v105
    v_cvt_pk_bf16_f32 v121, v106, v107
    v_mfma_f32_16x16x32_bf16 v[204:207], v[36:39], v[76:79], v[204:207]
    v_cvt_pk_bf16_f32 v122, v136, v137
    v_cvt_pk_bf16_f32 v123, v138, v139
    s_waitcnt lgkmcnt(0)
    v_mfma_f32_16x16x32_bf16 v[208:211], v[40:43], v[48:51], v[208:211]
    ds_read_b64_tr_b16 v[32:33], v10 offset:0
    buffer_store_dwordx4 v[120:123], v2, s[24:27], s6 offen offset:0 sc1
    v_max_f32 v108, 0, v108
    v_mfma_f32_16x16x32_bf16 v[208:211], v[44:47], v[64:67], v[208:211]
    v_max_f32 v109, 0, v109
    v_max_f32 v110, 0, v110
    v_max_f32 v111, 0, v111
    v_mfma_f32_16x16x32_bf16 v[212:215], v[40:43], v[52:55], v[212:215]
    ds_read_b64_tr_b16 v[34:35], v10 offset:1152
    v_pk_mul_f32 v[108:109], v[108:109], v[124:125]
    v_pk_mul_f32 v[110:111], v[110:111], v[126:127]
    v_mfma_f32_16x16x32_bf16 v[212:215], v[44:47], v[68:71], v[212:215]
    v_max_f32 v140, 0, v140
    v_max_f32 v141, 0, v141
    v_mfma_f32_16x16x32_bf16 v[216:219], v[40:43], v[56:59], v[216:219]
    ds_read_b64_tr_b16 v[36:37], v10 offset:19456
    v_max_f32 v142, 0, v142
    v_max_f32 v143, 0, v143
    v_mfma_f32_16x16x32_bf16 v[216:219], v[44:47], v[72:75], v[216:219]
    v_pk_mul_f32 v[140:141], v[140:141], v[156:157]
    v_pk_mul_f32 v[142:143], v[142:143], v[158:159]
    v_cvt_pk_bf16_f32 v124, v108, v109
    v_mfma_f32_16x16x32_bf16 v[220:223], v[40:43], v[60:63], v[220:223]
    ds_read_b64_tr_b16 v[38:39], v10 offset:20608
    v_cvt_pk_bf16_f32 v125, v110, v111
    v_cvt_pk_bf16_f32 v126, v140, v141
    v_mfma_f32_16x16x32_bf16 v[220:223], v[44:47], v[76:79], v[220:223]
    v_cvt_pk_bf16_f32 v127, v142, v143
    buffer_store_dwordx4 v[124:127], v2, s[24:27], s7 offen offset:0 sc1
    s_waitcnt lgkmcnt(0)
    v_mfma_f32_16x16x32_bf16 v[224:227], v[32:35], v[48:51], v[224:227]
    ds_read_b64_tr_b16 v[40:41], v10 offset:9728
    ds_read_b64_tr_b16 v[42:43], v10 offset:10880
    ds_read_b64_tr_b16 v[44:45], v10 offset:29184
    ds_read_b64_tr_b16 v[46:47], v10 offset:30336
    s_nop 3
    v_mfma_f32_16x16x32_bf16 v[224:227], v[36:39], v[64:67], v[224:227]
    v_max_f32 v160, 0, v160
    v_max_f32 v161, 0, v161
    v_max_f32 v162, 0, v162
    v_max_f32 v163, 0, v163
    v_mfma_f32_16x16x32_bf16 v[228:231], v[32:35], v[52:55], v[228:231]
    v_pk_mul_f32 v[160:161], v[160:161], v[176:177]
    v_pk_mul_f32 v[162:163], v[162:163], v[178:179]
    v_max_f32 v192, 0, v192
    v_max_f32 v193, 0, v193
    v_max_f32 v194, 0, v194
    v_mfma_f32_16x16x32_bf16 v[228:231], v[36:39], v[68:71], v[228:231]
    v_max_f32 v195, 0, v195
    v_pk_mul_f32 v[192:193], v[192:193], v[208:209]
    v_pk_mul_f32 v[194:195], v[194:195], v[210:211]
    v_cvt_pk_bf16_f32 v176, v160, v161
    v_mfma_f32_16x16x32_bf16 v[232:235], v[32:35], v[56:59], v[232:235]
    v_cvt_pk_bf16_f32 v177, v162, v163
    v_cvt_pk_bf16_f32 v178, v192, v193
    v_cvt_pk_bf16_f32 v179, v194, v195
    v_max_f32 v164, 0, v164
    v_max_f32 v165, 0, v165
    v_mfma_f32_16x16x32_bf16 v[232:235], v[36:39], v[72:75], v[232:235]
    v_max_f32 v166, 0, v166
    v_max_f32 v167, 0, v167
    v_pk_mul_f32 v[164:165], v[164:165], v[180:181]
    v_pk_mul_f32 v[166:167], v[166:167], v[182:183]
    v_mfma_f32_16x16x32_bf16 v[236:239], v[32:35], v[60:63], v[236:239]
    v_max_f32 v196, 0, v196
    v_max_f32 v197, 0, v197
    v_max_f32 v198, 0, v198
    v_max_f32 v199, 0, v199
    v_pk_mul_f32 v[196:197], v[196:197], v[212:213]
    v_mfma_f32_16x16x32_bf16 v[236:239], v[36:39], v[76:79], v[236:239]
    v_pk_mul_f32 v[198:199], v[198:199], v[214:215]
    v_cvt_pk_bf16_f32 v180, v164, v165
    v_cvt_pk_bf16_f32 v181, v166, v167
    v_cvt_pk_bf16_f32 v182, v196, v197
    s_waitcnt lgkmcnt(0)
    v_mfma_f32_16x16x32_bf16 v[240:243], v[40:43], v[48:51], v[240:243]
    v_cvt_pk_bf16_f32 v183, v198, v199
    v_max_f32 v168, 0, v168
    v_max_f32 v169, 0, v169
    v_max_f32 v170, 0, v170
    v_max_f32 v171, 0, v171
    v_mfma_f32_16x16x32_bf16 v[240:243], v[44:47], v[64:67], v[240:243]
    v_pk_mul_f32 v[168:169], v[168:169], v[184:185]
    v_pk_mul_f32 v[170:171], v[170:171], v[186:187]
    v_max_f32 v200, 0, v200
    v_max_f32 v201, 0, v201
    v_mfma_f32_16x16x32_bf16 v[244:247], v[40:43], v[52:55], v[244:247]
    v_max_f32 v202, 0, v202
    v_max_f32 v203, 0, v203
    v_pk_mul_f32 v[200:201], v[200:201], v[216:217]
    v_pk_mul_f32 v[202:203], v[202:203], v[218:219]
    v_mfma_f32_16x16x32_bf16 v[244:247], v[44:47], v[68:71], v[244:247]
    v_cvt_pk_bf16_f32 v184, v168, v169
    v_cvt_pk_bf16_f32 v185, v170, v171
    v_cvt_pk_bf16_f32 v186, v200, v201
    v_cvt_pk_bf16_f32 v187, v202, v203
    v_mfma_f32_16x16x32_bf16 v[248:251], v[40:43], v[56:59], v[248:251]
    v_max_f32 v172, 0, v172
    v_max_f32 v173, 0, v173
    v_max_f32 v174, 0, v174
    v_max_f32 v175, 0, v175
    v_mfma_f32_16x16x32_bf16 v[248:251], v[44:47], v[72:75], v[248:251]
    v_pk_mul_f32 v[172:173], v[172:173], v[188:189]
    v_pk_mul_f32 v[174:175], v[174:175], v[190:191]
    v_max_f32 v204, 0, v204
    v_max_f32 v205, 0, v205
    v_mfma_f32_16x16x32_bf16 v[252:255], v[40:43], v[60:63], v[252:255]
    v_max_f32 v206, 0, v206
    v_max_f32 v207, 0, v207
    v_pk_mul_f32 v[204:205], v[204:205], v[220:221]
    v_pk_mul_f32 v[206:207], v[206:207], v[222:223]
    v_mfma_f32_16x16x32_bf16 v[252:255], v[44:47], v[76:79], v[252:255]
    v_cvt_pk_bf16_f32 v188, v172, v173
    v_cvt_pk_bf16_f32 v189, v174, v175
    v_cvt_pk_bf16_f32 v190, v204, v205
    v_cvt_pk_bf16_f32 v191, v206, v207
    s_waitcnt vmcnt(0)
    v_mov_b32 v20, s62
    v_mov_b32 v21, 0
    s_mov_b64 exec, 1
    buffer_store_dword v20, v21, s[24:27], s63 offen sc1
    s_mov_b64 exec, -1
    s_add_u32 s63, s63, 8192
    s_barrier
    s_nop 6
    v_max_f32 v224, 0, v224
    v_max_f32 v225, 0, v225
    v_max_f32 v226, 0, v226
    v_max_f32 v227, 0, v227
    v_pk_mul_f32 v[224:225], v[224:225], v[240:241]
    v_pk_mul_f32 v[226:227], v[226:227], v[242:243]
    v_cvt_pk_bf16_f32 v240, v224, v225
    v_cvt_pk_bf16_f32 v241, v226, v227
    v_max_f32 v228, 0, v228
    v_max_f32 v229, 0, v229
    v_max_f32 v230, 0, v230
    v_max_f32 v231, 0, v231
    v_pk_mul_f32 v[228:229], v[228:229], v[244:245]
    v_pk_mul_f32 v[230:231], v[230:231], v[246:247]
    v_cvt_pk_bf16_f32 v244, v228, v229
    v_cvt_pk_bf16_f32 v245, v230, v231
    v_max_f32 v232, 0, v232
    v_max_f32 v233, 0, v233
    v_max_f32 v234, 0, v234
    v_max_f32 v235, 0, v235
    v_pk_mul_f32 v[232:233], v[232:233], v[248:249]
    v_pk_mul_f32 v[234:235], v[234:235], v[250:251]
    v_cvt_pk_bf16_f32 v248, v232, v233
    v_cvt_pk_bf16_f32 v249, v234, v235
    v_max_f32 v236, 0, v236
    v_max_f32 v237, 0, v237
    v_max_f32 v238, 0, v238
    v_max_f32 v239, 0, v239
    v_pk_mul_f32 v[236:237], v[236:237], v[252:253]
    v_pk_mul_f32 v[238:239], v[238:239], v[254:255]
    v_cvt_pk_bf16_f32 v252, v236, v237
    v_cvt_pk_bf16_f32 v253, v238, v239
    v_mov_b32 v224, v176
    v_mov_b32 v225, v177
    v_mov_b32 v226, v178
    v_mov_b32 v227, v179
    v_mov_b32 v228, v180
    v_mov_b32 v229, v181
    v_mov_b32 v230, v182
    v_mov_b32 v231, v183
    v_mov_b32 v232, v184
    v_mov_b32 v233, v185
    v_mov_b32 v234, v186
    v_mov_b32 v235, v187
    v_mov_b32 v236, v188
    v_mov_b32 v237, v189
    v_mov_b32 v238, v190
    v_mov_b32 v239, v191
    v_lshlrev_b32 v220, 3, v1
    s_branch K1_FIN
K1_P2:
    ds_read_b128 v[48:51], v88 offset:0
    ds_read_b128 v[52:55], v88 offset:2048
    ds_read_b128 v[56:59], v88 offset:4096
    ds_read_b128 v[60:63], v88 offset:6144
    ds_read_b64_tr_b16 v[32:33], v8 offset:0
    ds_read_b64_tr_b16 v[34:35], v8 offset:1152
    ds_read_b64_tr_b16 v[36:37], v8 offset:9728
    ds_read_b64_tr_b16 v[38:39], v8 offset:10880
K1_L2:
    s_waitcnt lgkmcnt(2)
    v_mfma_f32_16x16x32_bf16 v[96:99], v[32:35], v[48:51], v[96:99]
    ds_read_b128 v[64:67], v89 offset:0
    ds_read_b128 v[68:71], v89 offset:2048
    v_mfma_f32_16x16x32_bf16 v[100:103], v[32:35], v[52:55], v[100:103]
    ds_read_b64_tr_b16 v[40:41], v8 offset:32
    ds_read_b64_tr_b16 v[42:43], v8 offset:1184
    v_mfma_f32_16x16x32_bf16 v[104:107], v[32:35], v[56:59], v[104:107]
    ds_read_b64_tr_b16 v[44:45], v8 offset:9760
    ds_read_b64_tr_b16 v[46:47], v8 offset:10912
    v_mfma_f32_16x16x32_bf16 v[108:111], v[32:35], v[60:63], v[108:111]
    s_add_u32 m0, s44, 2048
    s_nop 0
    buffer_load_dwordx4 v2, s[16:19], s42 offen lds
    s_waitcnt lgkmcnt(6)
    v_mfma_f32_16x16x32_bf16 v[112:115], v[36:39], v[48:51], v[112:115]
    ds_read_b128 v[72:75], v89 offset:4096
    ds_read_b128 v[76:79], v89 offset:6144
    v_mfma_f32_16x16x32_bf16 v[116:119], v[36:39], v[52:55], v[116:119]
    v_xor_b32 v88, 32768, v88
    v_xor_b32 v89, 32768, v89
    v_mfma_f32_16x16x32_bf16 v[120:123], v[36:39], v[56:59], v[120:123]
    ds_read_b64_tr_b16 v[32:33], v8 offset:29216
    ds_read_b64_tr_b16 v[34:35], v8 offset:30368
    v_mfma_f32_16x16x32_bf16 v[124:127], v[36:39], v[60:63], v[124:127]
    s_add_u32 m0, s44, 3072
    s_nop 0
    buffer_load_dwordx4 v3, s[16:19], s42 offen lds
    s_add_u32 s41, s41, 128
    s_xor_b32 s44, s44, 32768
    s_cmp_ge_u32 s41, 1152
    s_cselect_b32 s41, 0x40000000, s41
    s_add_u32 s42, s41, 1179648
    s_waitcnt lgkmcnt(6)
    v_mfma_f32_16x16x32_bf16 v[128:131], v[40:43], v[48:51], v[128:131]
    ds_read_b64_tr_b16 v[36:37], v8 offset:64
    v_mfma_f32_16x16x32_bf16 v[132:135], v[40:43], v[52:55], v[132:135]
    ds_read_b64_tr_b16 v[38:39], v8 offset:1216
    v_mfma_f32_16x16x32_bf16 v[136:139], v[40:43], v[56:59], v[136:139]
    s_add_u32 m0, s45, 0
    s_nop 0
    buffer_load_dwordx4 v4, s[20:23], s43 offen lds
    v_mfma_f32_16x16x32_bf16 v[140:143], v[40:43], v[60:63], v[140:143]
    s_waitcnt lgkmcnt(2)
    v_mfma_f32_16x16x32_bf16 v[144:147], v[44:47], v[48:51], v[144:147]
    ds_read_b64_tr_b16 v[40:41], v8 offset:19520
    v_mfma_f32_16x16x32_bf16 v[144:147], v[32:35], v[64:67], v[144:147]
    ds_read_b128 v[224:227], v242
    v_mfma_f32_16x16x32_bf16 v[148:151], v[44:47], v[52:55], v[148:151]
    ds_read_b64_tr_b16 v[42:43], v8 offset:20672
    v_mfma_f32_16x16x32_bf16 v[148:151], v[32:35], v[68:71], v[148:151]
    ds_read_b128 v[228:231], v243
    v_mfma_f32_16x16x32_bf16 v[152:155], v[44:47], v[56:59], v[152:155]
    s_add_u32 m0, s45, 1024
    s_nop 0
    buffer_load_dwordx4 v5, s[20:23], s43 offen lds
    v_mfma_f32_16x16x32_bf16 v[152:155], v[32:35], v[72:75], v[152:155]
    v_xor_b32 v242, 32768, v242
    v_mfma_f32_16x16x32_bf16 v[156:159], v[44:47], v[60:63], v[156:159]
    s_add_u32 m0, s45, 2048
    s_mov_b64 exec, 0xffff
    buffer_load_dwordx4 v6, s[20:23], s43 offen lds
    s_mov_b64 exec, -1
    s_add_u32 s43, s43, 294912
    s_add_u32 s45, s45, 19456
    s_cmp_ge_u32 s45, 143360
    s_cselect_b32 s52, 77824, 0
    s_sub_u32 s45, s45, s52
    v_mfma_f32_16x16x32_bf16 v[156:159], v[32:35], v[76:79], v[156:159]
    v_add_u32 v243, 128, v243
    s_waitcnt lgkmcnt(1)
    v_mfma_f32_16x16x32_bf16 v[160:163], v[36:39], v[48:51], v[160:163]
    ds_read_b64_tr_b16 v[44:45], v8 offset:9792
    v_mfma_f32_16x16x32_bf16 v[160:163], v[40:43], v[64:67], v[160:163]
    ds_read_b64_tr_b16 v[46:47], v8 offset:10944
    v_mfma_f32_16x16x32_bf16 v[164:167], v[36:39], v[52:55], v[164:167]
    ds_read_b64_tr_b16 v[32:33], v8 offset:29248
    v_mfma_f32_16x16x32_bf16 v[164:167], v[40:43], v[68:71], v[164:167]
    v_mfma_f32_16x16x32_bf16 v[168:171], v[36:39], v[56:59], v[168:171]
    ds_read_b64_tr_b16 v[34:35], v8 offset:30400
    v_mfma_f32_16x16x32_bf16 v[168:171], v[40:43], v[72:75], v[168:171]
    s_add_u32 m0, s45, 0
    s_nop 0
    buffer_load_dwordx4 v4, s[20:23], s43 offen lds
    v_mfma_f32_16x16x32_bf16 v[172:175], v[36:39], v[60:63], v[172:175]
    s_add_u32 m0, s45, 1024
    s_nop 0
    buffer_load_dwordx4 v5, s[20:23], s43 offen lds
    v_mfma_f32_16x16x32_bf16 v[172:175], v[40:43], v[76:79], v[172:175]
    s_waitcnt lgkmcnt(0)
    v_mfma_f32_16x16x32_bf16 v[176:179], v[44:47], v[48:51], v[176:179]
    ds_read_b64_tr_b16 v[36:37], v8 offset:96
    v_lshlrev_b32 v232, 16, v224
    v_mfma_f32_16x16x32_bf16 v[176:179], v[32:35], v[64:67], v[176:179]
    v_and_b32 v233, 0xffff0000, v224
    ds_read_b64_tr_b16 v[38:39], v8 offset:1248
    v_mfma_f32_16x16x32_bf16 v[180:183], v[44:47], v[52:55], v[180:183]
    v_lshlrev_b32 v234, 16, v228
    v_and_b32 v235, 0xffff0000, v228
    v_mfma_f32_16x16x32_bf16 v[180:183], v[32:35], v[68:71], v[180:183]
    ds_read_b64_tr_b16 v[40:41], v8 offset:19552
    v_pk_mul_f32 v[232:233], v[232:233], v[234:235]
    v_mfma_f32_16x16x32_bf16 v[184:187], v[44:47], v[56:59], v[184:187]
    v_cvt_pk_bf16_f32 v234, v232, v233
    v_lshlrev_b32 v232, 16, v234
    v_mfma_f32_16x16x32_bf16 v[184:187], v[32:35], v[72:75], v[184:187]
    ds_read_b64_tr_b16 v[42:43], v8 offset:20704
    v_and_b32 v233, 0xffff0000, v234
    v_mfma_f32_16x16x32_bf16 v[188:191], v[44:47], v[60:63], v[188:191]
    v_pk_add_f32 v[240:241], v[240:241], v[232:233]
    s_add_u32 m0, s45, 2048
    s_mov_b64 exec, 0xffff
    buffer_load_dwordx4 v6, s[20:23], s43 offen lds
    s_mov_b64 exec, -1
    s_add_u32 s43, s43, 294912
    s_add_u32 s45, s45, 19456
    s_cmp_ge_u32 s45, 143360
    s_cselect_b32 s52, 77824, 0
    s_sub_u32 s45, s45, s52
    v_mfma_f32_16x16x32_bf16 v[188:191], v[32:35], v[76:79], v[188:191]
    v_lshlrev_b32 v236, 16, v225
    v_and_b32 v237, 0xffff0000, v225
    s_setprio 0
    s_waitcnt lgkmcnt(0)
    v_mfma_f32_16x16x32_bf16 v[192:195], v[36:39], v[48:51], v[192:195]
    ds_read_b64_tr_b16 v[44:45], v8 offset:9824
    v_lshlrev_b32 v238, 16, v229
    v_and_b32 v239, 0xffff0000, v229
    v_mfma_f32_16x16x32_bf16 v[192:195], v[40:43], v[64:67], v[192:195]
    v_pk_mul_f32 v[236:237], v[236:237], v[238:239]
    ds_read_b64_tr_b16 v[46:47], v8 offset:10976
    v_mfma_f32_16x16x32_bf16 v[196:199], v[36:39], v[52:55], v[196:199]
    v_cvt_pk_bf16_f32 v238, v236, v237
    v_lshlrev_b32 v236, 16, v238
    v_mfma_f32_16x16x32_bf16 v[196:199], v[40:43], v[68:71], v[196:199]
    ds_read_b64_tr_b16 v[32:33], v8 offset:29280
    v_and_b32 v237, 0xffff0000, v238
    v_mfma_f32_16x16x32_bf16 v[200:203], v[36:39], v[56:59], v[200:203]
    v_pk_add_f32 v[240:241], v[240:241], v[236:237]
    v_lshlrev_b32 v232, 16, v226
    v_mfma_f32_16x16x32_bf16 v[200:203], v[40:43], v[72:75], v[200:203]
    ds_read_b64_tr_b16 v[34:35], v8 offset:30432
    v_and_b32 v233, 0xffff0000, v226
    v_mfma_f32_16x16x32_bf16 v[204:207], v[36:39], v[60:63], v[204:207]
    v_lshlrev_b32 v234, 16, v230
    s_cmp_lg_u32 s47, s33
    s_cbranch_scc1 K1_S2_w
    s_mov_b32 exec_hi, 0x3fffff
    buffer_load_dword v94, v91, s[20:23], 0 offen
    s_mov_b32 exec_hi, -1
    s_branch K1_SE2
K1_S2_w:
    s_cmp_lg_u32 s47, 5
    s_cbranch_scc1 K1_S2_0
    s_mov_b32 m0, s60
    s_nop 0
    buffer_load_dwordx4 v29, s[28:31], s61 offen lds
    s_branch K1_SE2
K1_S2_0:
    s_cmp_lg_u32 s47, 4
    s_cbranch_scc1 K1_S2_1
    s_add_u32 m0, s60, 1024
    s_mov_b64 exec, 0xffff
    buffer_load_dwordx4 v30, s[28:31], s61 offen lds
    s_mov_b64 exec, -1
    s_branch K1_SE2
K1_S2_1:
    s_cmp_lg_u32 s47, 3
    s_cbranch_scc1 K1_S2_2
    s_mov_b64 exec, 0x1fffff
    buffer_load_dword v94, v90, s[96:99], s3 offen
    s_mov_b64 exec, -1
    s_branch K1_SE2
K1_S2_2:
    s_cmp_lg_u32 s47, 2
    s_cbranch_scc1 K1_S2_3
    v_mov_b32 v31, 0
    buffer_load_dword v31, v31, s[76:79], 0 offen sc1
    s_branch K1_SE2
K1_S2_3:
    s_cmp_lg_u32 s47, 1
    s_cbranch_scc1 K1_S2_4
    v_add_u32 v90, 540672, v11
    v_mov_b32 v91, 0x40000000
    v_cmp_gt_u32 vcc, s15, v0
    s_nop 1
    v_cndmask_b32 v90, v91, v90, vcc
    ds_read_u16 v80, v18 offset:0
    ds_read_u16 v84, v18 offset:5120
    ds_read_u16 v81, v18 offset:1280
    ds_read_u16 v85, v18 offset:6400
    ds_read_u16 v82, v18 offset:2560
    ds_read_u16 v86, v18 offset:7680
    ds_read_u16 v83, v18 offset:3840
    ds_read_u16 v87, v18 offset:8960
    s_waitcnt lgkmcnt(0)
    v_lshl_or_b32 v92, v84, 16, v80
    v_lshl_or_b32 v93, v85, 16, v81
    v_lshl_or_b32 v94, v86, 16, v82
    v_lshl_or_b32 v95, v87, 16, v83
    buffer_store_dwordx4 v[92:95], v11, s[24:27], s48 offen sc1
    s_branch K1_SE2
K1_S2_4:
    buffer_load_dword v95, v19, s[76:79], 0 offen
K1_SE2:
    v_mfma_f32_16x16x32_bf16 v[204:207], v[40:43], v[76:79], v[204:207]
    v_and_b32 v235, 0xffff0000, v230
    v_pk_mul_f32 v[232:233], v[232:233], v[234:235]
    s_waitcnt lgkmcnt(0)
    v_mfma_f32_16x16x32_bf16 v[208:211], v[44:47], v[48:51], v[208:211]
    ds_read_b64_tr_b16 v[36:37], v8 offset:19456
    v_cvt_pk_bf16_f32 v234, v232, v233
    v_lshlrev_b32 v232, 16, v234
    v_mfma_f32_16x16x32_bf16 v[208:211], v[32:35], v[64:67], v[208:211]
    v_and_b32 v233, 0xffff0000, v234
    v_pk_add_f32 v[240:241], v[240:241], v[232:233]
    v_mfma_f32_16x16x32_bf16 v[212:215], v[44:47], v[52:55], v[212:215]
    ds_read_b64_tr_b16 v[38:39], v8 offset:20608
    v_lshlrev_b32 v236, 16, v227
    v_mfma_f32_16x16x32_bf16 v[212:215], v[32:35], v[68:71], v[212:215]
    v_and_b32 v237, 0xffff0000, v227
    v_lshlrev_b32 v238, 16, v231
    v_mfma_f32_16x16x32_bf16 v[216:219], v[44:47], v[56:59], v[216:219]
    ds_read_b64_tr_b16 v[40:41], v8 offset:29184
    v_and_b32 v239, 0xffff0000, v231
    v_mfma_f32_16x16x32_bf16 v[216:219], v[32:35], v[72:75], v[216:219]
    v_pk_mul_f32 v[236:237], v[236:237], v[238:239]
    v_cvt_pk_bf16_f32 v238, v236, v237
    v_mfma_f32_16x16x32_bf16 v[220:223], v[44:47], v[60:63], v[220:223]
    ds_read_b64_tr_b16 v[42:43], v8 offset:30336
    v_lshlrev_b32 v236, 16, v238
    v_mfma_f32_16x16x32_bf16 v[220:223], v[32:35], v[76:79], v[220:223]
    v_and_b32 v237, 0xffff0000, v238
    v_pk_add_f32 v[240:241], v[240:241], v[236:237]
    s_waitcnt lgkmcnt(2)
    v_mfma_f32_16x16x32_bf16 v[96:99], v[36:39], v[64:67], v[96:99]
    ds_read_b64_tr_b16 v[44:45], v8 offset:19488
    v_mfma_f32_16x16x32_bf16 v[100:103], v[36:39], v[68:71], v[100:103]
    ds_read_b64_tr_b16 v[46:47], v8 offset:20640
    v_mfma_f32_16x16x32_bf16 v[104:107], v[36:39], v[72:75], v[104:107]
    s_xor_b32 s46, s46, 0x9800
    v_add_u32 v8, s46, v7
    v_mfma_f32_16x16x32_bf16 v[108:111], v[36:39], v[76:79], v[108:111]
    s_waitcnt vmcnt(1) lgkmcnt(0)
    s_barrier
    s_setprio 1
    v_mfma_f32_16x16x32_bf16 v[112:115], v[40:43], v[64:67], v[112:115]
    ds_read_b128 v[48:51], v88 offset:0
    ds_read_b128 v[52:55], v88 offset:2048
    ds_read_b128 v[56:59], v88 offset:4096
    v_mfma_f32_16x16x32_bf16 v[116:119], v[40:43], v[68:71], v[116:119]
    ds_read_b128 v[60:63], v88 offset:6144
    ds_read_b64_tr_b16 v[32:33], v8 offset:0
    v_mfma_f32_16x16x32_bf16 v[120:123], v[40:43], v[72:75], v[120:123]
    ds_read_b64_tr_b16 v[34:35], v8 offset:1152
    ds_read_b64_tr_b16 v[36:37], v8 offset:9728
    v_mfma_f32_16x16x32_bf16 v[124:127], v[40:43], v[76:79], v[124:127]
    ds_read_b64_tr_b16 v[38:39], v8 offset:10880
    s_add_u32 m0, s44, 0
    s_nop 0
    buffer_load_dwordx4 v2, s[16:19], s41 offen lds
    v_mfma_f32_16x16x32_bf16 v[128:131], v[44:47], v[64:67], v[128:131]
    s_add_u32 m0, s44, 1024
    s_nop 0
    buffer_load_dwordx4 v3, s[16:19], s41 offen lds
    v_mfma_f32_16x16x32_bf16 v[132:135], v[44:47], v[68:71], v[132:135]
    v_mfma_f32_16x16x32_bf16 v[136:139], v[44:47], v[72:75], v[136:139]
    v_mfma_f32_16x16x32_bf16 v[140:143], v[44:47], v[76:79], v[140:143]
    s_sub_u32 s47, s47, 1
    s_cmp_lg_u32 s47, 0
    s_cbranch_scc1 K1_L2
    v_lshlrev_b32 v2, 4, v1
    s_waitcnt lgkmcnt(2)
    v_mfma_f32_16x16x32_bf16 v[96:99], v[32:35], v[48:51], v[96:99]
    ds_read_b128 v[64:67], v89 offset:0
    ds_read_b128 v[224:227], v242
    ds_read_b128 v[68:71], v89 offset:2048
    v_mfma_f32_16x16x32_bf16 v[100:103], v[32:35], v[52:55], v[100:103]
    ds_read_b128 v[72:75], v89 offset:4096
    ds_read_b128 v[228:231], v243
    ds_read_b128 v[76:79], v89 offset:6144
    v_mfma_f32_16x16x32_bf16 v[104:107], v[32:35], v[56:59], v[104:107]
    ds_read_b64_tr_b16 v[40:41], v8 offset:32
    v_xor_b32 v242, 32768, v242
    ds_read_b64_tr_b16 v[42:43], v8 offset:1184
    v_mfma_f32_16x16x32_bf16 v[108:111], v[32:35], v[60:63], v[108:111]
    ds_read_b64_tr_b16 v[44:45], v8 offset:19488
    v_add_u32 v243, 128, v243
    ds_read_b64_tr_b16 v[46:47], v8 offset:20640
    s_waitcnt lgkmcnt(10)
    v_mfma_f32_16x16x32_bf16 v[112:115], v[36:39], v[48:51], v[112:115]
    ds_read_b64_tr_b16 v[32:33], v8 offset:9760
    v_mfma_f32_16x16x32_bf16 v[116:119], v[36:39], v[52:55], v[116:119]
    v_mfma_f32_16x16x32_bf16 v[120:123], v[36:39], v[56:59], v[120:123]
    ds_read_b64_tr_b16 v[34:35], v8 offset:10912
    v_mfma_f32_16x16x32_bf16 v[124:127], v[36:39], v[60:63], v[124:127]
    s_waitcnt lgkmcnt(2)
    v_mfma_f32_16x16x32_bf16 v[128:131], v[40:43], v[48:51], v[128:131]
    ds_read_b64_tr_b16 v[36:37], v8 offset:29216
    v_lshlrev_b32 v232, 16, v224
    v_mfma_f32_16x16x32_bf16 v[128:131], v[44:47], v[64:67], v[128:131]
    v_and_b32 v233, 0xffff0000, v224
    v_lshlrev_b32 v234, 16, v228
    v_mfma_f32_16x16x32_bf16 v[132:135], v[40:43], v[52:55], v[132:135]
    v_and_b32 v235, 0xffff0000, v228
    v_pk_mul_f32 v[232:233], v[232:233], v[234:235]
    v_cvt_pk_bf16_f32 v234, v232, v233
    v_mfma_f32_16x16x32_bf16 v[132:135], v[44:47], v[68:71], v[132:135]
    v_lshlrev_b32 v232, 16, v234
    v_and_b32 v233, 0xffff0000, v234
    v_mfma_f32_16x16x32_bf16 v[136:139], v[40:43], v[56:59], v[136:139]
    ds_read_b64_tr_b16 v[38:39], v8 offset:30368
    v_pk_add_f32 v[240:241], v[240:241], v[232:233]
    v_lshlrev_b32 v236, 16, v225
    v_mfma_f32_16x16x32_bf16 v[136:139], v[44:47], v[72:75], v[136:139]
    v_and_b32 v237, 0xffff0000, v225
    v_lshlrev_b32 v238, 16, v229
    v_mfma_f32_16x16x32_bf16 v[140:143], v[40:43], v[60:63], v[140:143]
    v_and_b32 v239, 0xffff0000, v229
    v_pk_mul_f32 v[236:237], v[236:237], v[238:239]
    v_cvt_pk_bf16_f32 v238, v236, v237
    v_mfma_f32_16x16x32_bf16 v[140:143], v[44:47], v[76:79], v[140:143]
    v_lshlrev_b32 v236, 16, v238
    v_and_b32 v237, 0xffff0000, v238
    s_waitcnt lgkmcnt(0)
    v_mfma_f32_16x16x32_bf16 v[144:147], v[32:35], v[48:51], v[144:147]
    ds_read_b64_tr_b16 v[40:41], v8 offset:19456
    v_pk_add_f32 v[240:241], v[240:241], v[236:237]
    v_lshlrev_b32 v232, 16, v226
    v_mfma_f32_16x16x32_bf16 v[144:147], v[36:39], v[64:67], v[144:147]
    v_and_b32 v233, 0xffff0000, v226
    v_lshlrev_b32 v234, 16, v230
    v_and_b32 v235, 0xffff0000, v230
    v_mfma_f32_16x16x32_bf16 v[148:151], v[32:35], v[52:55], v[148:151]
    ds_read_b64_tr_b16 v[42:43], v8 offset:20608
    v_pk_mul_f32 v[232:233], v[232:233], v[234:235]
    v_cvt_pk_bf16_f32 v234, v232, v233
    v_mfma_f32_16x16x32_bf16 v[148:151], v[36:39], v[68:71], v[148:151]
    v_lshlrev_b32 v232, 16, v234
    v_and_b32 v233, 0xffff0000, v234
    v_pk_add_f32 v[240:241], v[240:241], v[232:233]
    v_mfma_f32_16x16x32_bf16 v[152:155], v[32:35], v[56:59], v[152:155]
    ds_read_b64_tr_b16 v[44:45], v8 offset:29184
    v_lshlrev_b32 v236, 16, v227
    v_and_b32 v237, 0xffff0000, v227
    v_mfma_f32_16x16x32_bf16 v[152:155], v[36:39], v[72:75], v[152:155]
    v_lshlrev_b32 v238, 16, v231
    v_and_b32 v239, 0xffff0000, v231
    v_pk_mul_f32 v[236:237], v[236:237], v[238:239]
    v_mfma_f32_16x16x32_bf16 v[156:159], v[32:35], v[60:63], v[156:159]
    ds_read_b64_tr_b16 v[46:47], v8 offset:30336
    v_cvt_pk_bf16_f32 v238, v236, v237
    v_lshlrev_b32 v236, 16, v238
    v_mfma_f32_16x16x32_bf16 v[156:159], v[36:39], v[76:79], v[156:159]
    v_and_b32 v237, 0xffff0000, v238
    v_pk_add_f32 v[240:241], v[240:241], v[236:237]
    s_waitcnt lgkmcnt(2)
    v_mfma_f32_16x16x32_bf16 v[96:99], v[40:43], v[64:67], v[96:99]
    ds_read_b64_tr_b16 v[32:33], v8 offset:64
    v_add_f32 v240, v240, v241
    s_nop 1
    v_add_f32_dpp v240, v240, v240 quad_perm:[1,0,3,2] row_mask:0xf bank_mask:0xf
    s_nop 1
    v_mfma_f32_16x16x32_bf16 v[100:103], v[40:43], v[68:71], v[100:103]
    ds_read_b64_tr_b16 v[34:35], v8 offset:1216
    v_add_f32_dpp v240, v240, v240 quad_perm:[2,3,0,1] row_mask:0xf bank_mask:0xf
    s_nop 1
    v_add_f32_dpp v240, v240, v240 row_half_mirror row_mask:0xf bank_mask:0xf
    v_mfma_f32_16x16x32_bf16 v[104:107], v[40:43], v[72:75], v[104:107]
    ds_read_b64_tr_b16 v[36:37], v8 offset:19520
    v_cvt_pk_bf16_f32 v240, v240, v240
    v_lshlrev_b32 v240, 16, v240
    v_mul_f32 v240, 0xbfb8aa3b, v240
    v_exp_f32 v240, v240
    v_mfma_f32_16x16x32_bf16 v[108:111], v[40:43], v[76:79], v[108:111]
    ds_read_b64_tr_b16 v[38:39], v8 offset:20672
    s_nop 0
    v_add_f32 v240, 1.0, v240
    v_rcp_f32 v240, v240
    s_waitcnt lgkmcnt(4)
    v_mfma_f32_16x16x32_bf16 v[112:115], v[44:47], v[64:67], v[112:115]
    ds_read_b64_tr_b16 v[40:41], v8 offset:9792
    s_nop 0
    v_cvt_pk_bf16_f32 v240, v240, v240
    v_lshlrev_b32 v240, 16, v240
    v_mfma_f32_16x16x32_bf16 v[116:119], v[44:47], v[68:71], v[116:119]
    v_sub_f32 v241, 1.0, v240
    v_cvt_pk_bf16_f32 v241, v241, v241
    v_lshlrev_b32 v241, 16, v241
    v_bfe_u32 v232, v242, 7, 8
    v_mfma_f32_16x16x32_bf16 v[120:123], v[44:47], v[72:75], v[120:123]
    ds_read_b64_tr_b16 v[42:43], v8 offset:10944
    v_lshlrev_b32 v232, 2, v232
    s_lshl_b32 s52, s37, 10
    s_add_u32 s52, s52, 36937984
    v_mfma_f32_16x16x32_bf16 v[124:127], v[44:47], v[76:79], v[124:127]
    s_add_u32 s53, s52, 8192
    s_mov_b32 s54, 0x01010101
    s_mov_b32 s55, 0x01010101
    s_mov_b64 exec, s[54:55]
    buffer_store_dword v240, v232, s[24:27], s52 offen sc1
    buffer_store_dword v241, v232, s[24:27], s53 offen sc1
    s_mov_b64 exec, -1
    s_waitcnt lgkmcnt(2)
    v_mfma_f32_16x16x32_bf16 v[160:163], v[32:35], v[48:51], v[160:163]
    ds_read_b64_tr_b16 v[44:45], v8 offset:29248
    ds_read_b64_tr_b16 v[46:47], v8 offset:30400
    s_nop 3
    v_mfma_f32_16x16x32_bf16 v[160:163], v[36:39], v[64:67], v[160:163]
    v_max_f32 v96, 0, v96
    v_max_f32 v97, 0, v97
    v_mfma_f32_16x16x32_bf16 v[164:167], v[32:35], v[52:55], v[164:167]
    v_max_f32 v98, 0, v98
    v_max_f32 v99, 0, v99
    v_pk_mul_f32 v[96:97], v[96:97], v[112:113]
    v_mfma_f32_16x16x32_bf16 v[164:167], v[36:39], v[68:71], v[164:167]
    v_pk_mul_f32 v[98:99], v[98:99], v[114:115]
    v_max_f32 v128, 0, v128
    v_mfma_f32_16x16x32_bf16 v[168:171], v[32:35], v[56:59], v[168:171]
    v_max_f32 v129, 0, v129
    v_max_f32 v130, 0, v130
    v_mfma_f32_16x16x32_bf16 v[168:171], v[36:39], v[72:75], v[168:171]
    v_max_f32 v131, 0, v131
    v_pk_mul_f32 v[128:129], v[128:129], v[144:145]
    v_pk_mul_f32 v[130:131], v[130:131], v[146:147]
    v_mfma_f32_16x16x32_bf16 v[172:175], v[32:35], v[60:63], v[172:175]
    v_cvt_pk_bf16_f32 v112, v96, v97
    v_cvt_pk_bf16_f32 v113, v98, v99
    v_mfma_f32_16x16x32_bf16 v[172:175], v[36:39], v[76:79], v[172:175]
    v_cvt_pk_bf16_f32 v114, v128, v129
    v_cvt_pk_bf16_f32 v115, v130, v131
    s_waitcnt lgkmcnt(0)
    v_mfma_f32_16x16x32_bf16 v[176:179], v[40:43], v[48:51], v[176:179]
    ds_read_b64_tr_b16 v[32:33], v8 offset:96
    buffer_store_dwordx4 v[112:115], v2, s[24:27], s4 offen offset:0 sc1
    v_max_f32 v100, 0, v100
    v_mfma_f32_16x16x32_bf16 v[176:179], v[44:47], v[64:67], v[176:179]
    v_max_f32 v101, 0, v101
    v_max_f32 v102, 0, v102
    v_max_f32 v103, 0, v103
    v_mfma_f32_16x16x32_bf16 v[180:183], v[40:43], v[52:55], v[180:183]
    ds_read_b64_tr_b16 v[34:35], v8 offset:1248
    v_pk_mul_f32 v[100:101], v[100:101], v[116:117]
    v_mfma_f32_16x16x32_bf16 v[180:183], v[44:47], v[68:71], v[180:183]
    v_pk_mul_f32 v[102:103], v[102:103], v[118:119]
    v_max_f32 v132, 0, v132
    v_max_f32 v133, 0, v133
    v_mfma_f32_16x16x32_bf16 v[184:187], v[40:43], v[56:59], v[184:187]
    ds_read_b64_tr_b16 v[36:37], v8 offset:19552
    v_max_f32 v134, 0, v134
    v_max_f32 v135, 0, v135
    v_mfma_f32_16x16x32_bf16 v[184:187], v[44:47], v[72:75], v[184:187]
    v_pk_mul_f32 v[132:133], v[132:133], v[148:149]
    v_pk_mul_f32 v[134:135], v[134:135], v[150:151]
    v_mfma_f32_16x16x32_bf16 v[188:191], v[40:43], v[60:63], v[188:191]
    ds_read_b64_tr_b16 v[38:39], v8 offset:20704
    v_cvt_pk_bf16_f32 v116, v100, v101
    v_cvt_pk_bf16_f32 v117, v102, v103
    v_mfma_f32_16x16x32_bf16 v[188:191], v[44:47], v[76:79], v[188:191]
    v_cvt_pk_bf16_f32 v118, v132, v133
    v_cvt_pk_bf16_f32 v119, v134, v135
    s_waitcnt lgkmcnt(0)
    v_mfma_f32_16x16x32_bf16 v[192:195], v[32:35], v[48:51], v[192:195]
    ds_read_b64_tr_b16 v[40:41], v8 offset:9824
    s_mov_b32 s58, 65536
K1_TAG2:
    v_readfirstlane_b32 s62, v31
    s_cmp_lg_u32 s62, 0
    s_cbranch_scc1 K1_TAG2_OK
    s_sleep 8
    v_mov_b32 v31, 0
    buffer_load_dword v31, v31, s[76:79], 0 offen sc1
    s_waitcnt vmcnt(0)
    s_sub_u32 s58, s58, 1
    s_cmp_lg_u32 s58, 0
    s_cbranch_scc1 K1_TAG2
K1_TAG2_OK:
    s_waitcnt vmcnt(1)
    v_mov_b32 v20, s62
    v_mov_b32 v21, 0
    s_mov_b64 exec, 1
    buffer_store_dword v20, v21, s[24:27], s63 offen sc1
    s_mov_b64 exec, -1
    s_add_u32 s63, s63, 8192
    v_mfma_f32_16x16x32_bf16 v[192:195], v[36:39], v[64:67], v[192:195]
    buffer_store_dwordx4 v[116:119], v2, s[24:27], s5 offen offset:0 sc1
    v_max_f32 v104, 0, v104
    v_max_f32 v105, 0, v105
    v_mfma_f32_16x16x32_bf16 v[196:199], v[32:35], v[52:55], v[196:199]
    ds_read_b64_tr_b16 v[42:43], v8 offset:10976
    v_max_f32 v106, 0, v106
    v_max_f32 v107, 0, v107
    v_mfma_f32_16x16x32_bf16 v[196:199], v[36:39], v[68:71], v[196:199]
    v_pk_mul_f32 v[104:105], v[104:105], v[120:121]
    v_pk_mul_f32 v[106:107], v[106:107], v[122:123]
    v_max_f32 v136, 0, v136
    v_mfma_f32_16x16x32_bf16 v[200:203], v[32:35], v[56:59], v[200:203]
    ds_read_b64_tr_b16 v[44:45], v8 offset:29280
    v_max_f32 v137, 0, v137
    v_max_f32 v138, 0, v138
    v_mfma_f32_16x16x32_bf16 v[200:203], v[36:39], v[72:75], v[200:203]
    v_max_f32 v139, 0, v139
    v_pk_mul_f32 v[136:137], v[136:137], v[152:153]
    v_pk_mul_f32 v[138:139], v[138:139], v[154:155]
    v_mfma_f32_16x16x32_bf16 v[204:207], v[32:35], v[60:63], v[204:207]
    ds_read_b64_tr_b16 v[46:47], v8 offset:30432
    v_cvt_pk_bf16_f32 v120, v104, v105
    v_cvt_pk_bf16_f32 v121, v106, v107
    v_mfma_f32_16x16x32_bf16 v[204:207], v[36:39], v[76:79], v[204:207]
    v_cvt_pk_bf16_f32 v122, v136, v137
    v_cvt_pk_bf16_f32 v123, v138, v139
    s_waitcnt lgkmcnt(0)
    v_mfma_f32_16x16x32_bf16 v[208:211], v[40:43], v[48:51], v[208:211]
    buffer_store_dwordx4 v[120:123], v2, s[24:27], s6 offen offset:0 sc1
    v_max_f32 v108, 0, v108
    v_max_f32 v109, 0, v109
    v_mfma_f32_16x16x32_bf16 v[208:211], v[44:47], v[64:67], v[208:211]
    v_max_f32 v110, 0, v110
    v_max_f32 v111, 0, v111
    v_mfma_f32_16x16x32_bf16 v[212:215], v[40:43], v[52:55], v[212:215]
    v_pk_mul_f32 v[108:109], v[108:109], v[124:125]
    v_pk_mul_f32 v[110:111], v[110:111], v[126:127]
    v_mfma_f32_16x16x32_bf16 v[212:215], v[44:47], v[68:71], v[212:215]
    v_max_f32 v140, 0, v140
    v_max_f32 v141, 0, v141
    v_mfma_f32_16x16x32_bf16 v[216:219], v[40:43], v[56:59], v[216:219]
    v_max_f32 v142, 0, v142
    v_max_f32 v143, 0, v143
    v_pk_mul_f32 v[140:141], v[140:141], v[156:157]
    v_mfma_f32_16x16x32_bf16 v[216:219], v[44:47], v[72:75], v[216:219]
    v_pk_mul_f32 v[142:143], v[142:143], v[158:159]
    v_cvt_pk_bf16_f32 v124, v108, v109
    v_mfma_f32_16x16x32_bf16 v[220:223], v[40:43], v[60:63], v[220:223]
    v_cvt_pk_bf16_f32 v125, v110, v111
    v_cvt_pk_bf16_f32 v126, v140, v141
    v_mfma_f32_16x16x32_bf16 v[220:223], v[44:47], v[76:79], v[220:223]
    v_cvt_pk_bf16_f32 v127, v142, v143
    buffer_store_dwordx4 v[124:127], v2, s[24:27], s7 offen offset:0 sc1
    s_waitcnt vmcnt(0)
    v_mov_b32 v20, s62
    v_mov_b32 v21, 0
    s_mov_b64 exec, 1
    buffer_store_dword v20, v21, s[24:27], s63 offen sc1
    s_mov_b64 exec, -1
    s_add_u32 s63, s63, 8192
    s_barrier
    s_nop 6
    v_max_f32 v160, 0, v160
    v_max_f32 v161, 0, v161
    v_max_f32 v162, 0, v162
    v_max_f32 v163, 0, v163
    v_pk_mul_f32 v[160:161], v[160:161], v[176:177]
    v_pk_mul_f32 v[162:163], v[162:163], v[178:179]
    v_max_f32 v192, 0, v192
    v_max_f32 v193, 0, v193
    v_max_f32 v194, 0, v194
    v_max_f32 v195, 0, v195
    v_pk_mul_f32 v[192:193], v[192:193], v[208:209]
    v_pk_mul_f32 v[194:195], v[194:195], v[210:211]
    v_cvt_pk_bf16_f32 v176, v160, v161
    v_cvt_pk_bf16_f32 v177, v162, v163
    v_cvt_pk_bf16_f32 v178, v192, v193
    v_cvt_pk_bf16_f32 v179, v194, v195
    v_max_f32 v164, 0, v164
    v_max_f32 v165, 0, v165
    v_max_f32 v166, 0, v166
    v_max_f32 v167, 0, v167
    v_pk_mul_f32 v[164:165], v[164:165], v[180:181]
    v_pk_mul_f32 v[166:167], v[166:167], v[182:183]
    v_max_f32 v196, 0, v196
    v_max_f32 v197, 0, v197
    v_max_f32 v198, 0, v198
    v_max_f32 v199, 0, v199
    v_pk_mul_f32 v[196:197], v[196:197], v[212:213]
    v_pk_mul_f32 v[198:199], v[198:199], v[214:215]
    v_cvt_pk_bf16_f32 v180, v164, v165
    v_cvt_pk_bf16_f32 v181, v166, v167
    v_cvt_pk_bf16_f32 v182, v196, v197
    v_cvt_pk_bf16_f32 v183, v198, v199
    v_max_f32 v168, 0, v168
    v_max_f32 v169, 0, v169
    v_max_f32 v170, 0, v170
    v_max_f32 v171, 0, v171
    v_pk_mul_f32 v[168:169], v[168:169], v[184:185]
    v_pk_mul_f32 v[170:171], v[170:171], v[186:187]
    v_max_f32 v200, 0, v200
    v_max_f32 v201, 0, v201
    v_max_f32 v202, 0, v202
    v_max_f32 v203, 0, v203
    v_pk_mul_f32 v[200:201], v[200:201], v[216:217]
    v_pk_mul_f32 v[202:203], v[202:203], v[218:219]
    v_cvt_pk_bf16_f32 v184, v168, v169
    v_cvt_pk_bf16_f32 v185, v170, v171
    v_cvt_pk_bf16_f32 v186, v200, v201
    v_cvt_pk_bf16_f32 v187, v202, v203
    v_max_f32 v172, 0, v172
    v_max_f32 v173, 0, v173
    v_max_f32 v174, 0, v174
    v_max_f32 v175, 0, v175
    v_pk_mul_f32 v[172:173], v[172:173], v[188:189]
    v_pk_mul_f32 v[174:175], v[174:175], v[190:191]
    v_max_f32 v204, 0, v204
    v_max_f32 v205, 0, v205
    v_max_f32 v206, 0, v206
    v_max_f32 v207, 0, v207
    v_pk_mul_f32 v[204:205], v[204:205], v[220:221]
    v_pk_mul_f32 v[206:207], v[206:207], v[222:223]
    v_cvt_pk_bf16_f32 v188, v172, v173
    v_cvt_pk_bf16_f32 v189, v174, v175
    v_cvt_pk_bf16_f32 v190, v204, v205
    v_cvt_pk_bf16_f32 v191, v206, v207
K1_FIN:
    s_setprio 0
    s_and_b32 s52, s2, 7
    s_lshr_b32 s53, s2, 3
    s_cmp_ge_u32 s53, 24
    s_cbranch_scc1 K2_FFT
    s_and_b32 s28, s38, 7
    s_and_b32 s54, s28, 1
    s_lshr_b32 s55, s40, 1
    s_cmp_lg_u32 s54, s55
    s_cbranch_scc1 K2_NOOWN
    s_xor_b32 s55, s54, s39
    s_xor_b32 s55, s55, 1
    s_lshl_b32 s55, s55, 1
    s_and_b32 s56, s40, 1
    s_add_u32 s55, s55, s56
    s_lshl_b32 s55, s55, 12
    s_add_u32 s55, s55, 24576
    v_add_u32 v16, s55, v2
    ds_write_b128 v16, v[112:115] offset:0
    ds_write_b128 v16, v[116:119] offset:1024
    ds_write_b128 v16, v[120:123] offset:2048
    ds_write_b128 v16, v[124:127] offset:3072
    ds_write_b128 v16, v[176:179] offset:40960
    ds_write_b128 v16, v[180:183] offset:41984
    ds_write_b128 v16, v[184:187] offset:43008
    ds_write_b128 v16, v[188:191] offset:44032
K2_NOOWN:
    s_lshl_b32 s56, s37, 1
    s_lshr_b32 s37, s52, 1
    s_add_u32 s38, s56, s54
    s_lshr_b32 s39, s28, 1
    s_cmp_ge_u32 s36, 4
    s_cbranch_scc1 K2_LOAD
    s_and_b32 s55, s36, 1
    s_lshr_b32 s56, s36, 1
    v_lshrrev_b32 v16, 2, v1
    v_mul_u32_u24 v17, 384, v16
    v_and_b32 v18, 3, v1
    v_lshl_add_u32 v17, v18, 3, v17
    v_bfe_u32 v16, v1, 3, 2
    s_mul_i32 s52, s56, 6
    s_add_u32 s53, s52, 0
    v_xor_b32 v18, s53, v16
    v_lshl_add_u32 v8, v18, 5, v17
    v_mov_b32 v4, v8
    s_add_u32 s53, s52, 1
    v_xor_b32 v18, s53, v16
    v_lshl_add_u32 v9, v18, 5, v17
    v_mov_b32 v5, v9
    s_add_u32 s53, s52, 2
    v_xor_b32 v18, s53, v16
    v_lshl_add_u32 v10, v18, 5, v17
    v_mov_b32 v6, v10
    s_add_u32 s53, s52, 3
    v_xor_b32 v18, s53, v16
    v_lshl_add_u32 v11, v18, 5, v17
    v_mov_b32 v7, v11
    s_lshl_b32 s52, s55, 12
    s_add_u32 s52, s52, 24576
    v_add_u32 v13, s52, v2
    v_mov_b32 v12, v13
    s_mov_b32 s44, 0
    s_lshl_b32 s52, s38, 1
    s_add_u32 s52, s52, s55
    s_mul_i32 s52, s52, 77824
    s_mul_i32 s48, s37, 2490368
    s_add_u32 s48, s48, s52
    s_lshl_b32 s52, s39, 1
    s_add_u32 s52, s52, s56
    s_mul_i32 s52, s52, 3072
    s_add_u32 s48, s48, s52
    s_add_u32 s48, s48, 26312960
    s_add_u32 s49, s48, 19456
    s_add_u32 s50, s48, 38912
    s_add_u32 s51, s48, 58368
    v_lshrrev_b32 v16, 2, v1
    v_lshlrev_b32 v17, 8, v16
    v_and_b32 v18, 3, v1
    v_lshl_add_u32 v17, v18, 3, v17
    v_add_u32 v17, 106496, v17
    v_and_b32 v16, 7, v16
    s_lshl_b32 s52, s55, 2
    s_add_u32 s53, s52, 0
    v_xor_b32 v18, s53, v16
    v_lshl_add_u32 v208, v18, 5, v17
    s_add_u32 s53, s52, 1
    v_xor_b32 v18, s53, v16
    v_lshl_add_u32 v209, v18, 5, v17
    s_add_u32 s53, s52, 2
    v_xor_b32 v18, s53, v16
    v_lshl_add_u32 v210, v18, 5, v17
    s_add_u32 s53, s52, 3
    v_xor_b32 v18, s53, v16
    v_lshl_add_u32 v211, v18, 5, v17
    v_lshrrev_b32 v16, 1, v1
    v_mul_u32_u24 v16, 4224, v16
    v_and_b32 v17, 1, v1
    v_lshl_add_u32 v218, v17, 11, v16
    s_lshl_b32 s60, s37, 2
    s_add_u32 s60, s60, s36
    s_mul_i32 s60, s60, 152064
    s_lshl_b32 s52, s38, 7
    s_add_u32 s60, s60, s52
    s_add_u32 s60, s60, 23879936
    s_add_u32 s59, s60, 135168
    v_and_b32 v215, 15, v1
    v_lshlrev_b32 v215, 2, v215
    s_lshl_b32 s61, s38, 1
    s_add_u32 s61, s61, s55
    s_lshl_b32 s61, s61, 8
    s_add_u32 s61, s61, 36946176
    v_mov_b32 v96, 0
    v_mov_b32 v97, 0
    v_mov_b32 v98, 0
    v_mov_b32 v99, 0
    v_mov_b32 v100, 0
    v_mov_b32 v101, 0
    v_mov_b32 v102, 0
    v_mov_b32 v103, 0
    v_mov_b32 v104, 0
    v_mov_b32 v105, 0
    v_mov_b32 v106, 0
    v_mov_b32 v107, 0
    v_mov_b32 v108, 0
    v_mov_b32 v109, 0
    v_mov_b32 v110, 0
    v_mov_b32 v111, 0
    v_mov_b32 v112, 0
    v_mov_b32 v113, 0
    v_mov_b32 v114, 0
    v_mov_b32 v115, 0
    v_mov_b32 v116, 0
    v_mov_b32 v117, 0
    v_mov_b32 v118, 0
    v_mov_b32 v119, 0
    v_mov_b32 v120, 0
    v_mov_b32 v121, 0
    v_mov_b32 v122, 0
    v_mov_b32 v123, 0
    v_mov_b32 v124, 0
    v_mov_b32 v125, 0
    v_mov_b32 v126, 0
    v_mov_b32 v127, 0
    v_mov_b32 v128, 0
    v_mov_b32 v129, 0
    v_mov_b32 v130, 0
    v_mov_b32 v131, 0
    v_mov_b32 v132, 0
    v_mov_b32 v133, 0
    v_mov_b32 v134, 0
    v_mov_b32 v135, 0
    v_mov_b32 v136, 0
    v_mov_b32 v137, 0
    v_mov_b32 v138, 0
    v_mov_b32 v139, 0
    v_mov_b32 v140, 0
    v_mov_b32 v141, 0
    v_mov_b32 v142, 0
    v_mov_b32 v143, 0
    v_mov_b32 v144, 0
    v_mov_b32 v145, 0
    v_mov_b32 v146, 0
    v_mov_b32 v147, 0
    v_mov_b32 v148, 0
    v_mov_b32 v149, 0
    v_mov_b32 v150, 0
    v_mov_b32 v151, 0
    v_mov_b32 v152, 0
    v_mov_b32 v153, 0
    v_mov_b32 v154, 0
    v_mov_b32 v155, 0
    v_mov_b32 v156, 0
    v_mov_b32 v157, 0
    v_mov_b32 v158, 0
    v_mov_b32 v159, 0
    v_mov_b32 v160, 0
    v_mov_b32 v161, 0
    v_mov_b32 v162, 0
    v_mov_b32 v163, 0
    v_mov_b32 v164, 0
    v_mov_b32 v165, 0
    v_mov_b32 v166, 0
    v_mov_b32 v167, 0
    v_mov_b32 v168, 0
    v_mov_b32 v169, 0
    v_mov_b32 v170, 0
    v_mov_b32 v171, 0
    v_mov_b32 v172, 0
    v_mov_b32 v173, 0
    v_mov_b32 v174, 0
    v_mov_b32 v175, 0
    v_mov_b32 v176, 0
    v_mov_b32 v177, 0
    v_mov_b32 v178, 0
    v_mov_b32 v179, 0
    v_mov_b32 v180, 0
    v_mov_b32 v181, 0
    v_mov_b32 v182, 0
    v_mov_b32 v183, 0
    v_mov_b32 v184, 0
    v_mov_b32 v185, 0
    v_mov_b32 v186, 0
    v_mov_b32 v187, 0
    v_mov_b32 v188, 0
    v_mov_b32 v189, 0
    v_mov_b32 v190, 0
    v_mov_b32 v191, 0
    s_mov_b32 s43, 15
    s_waitcnt lgkmcnt(0)
    s_barrier
    ds_read_b128 v[32:35], v12 offset:0
    ds_read_b128 v[36:39], v12 offset:1024
    ds_read_b64_tr_b16 v[16:17], v4 offset:0
    ds_read_b64_tr_b16 v[18:19], v4 offset:6144
    ds_read_b128 v[40:43], v12 offset:2048
    ds_read_b128 v[44:47], v12 offset:3072
    ds_read_b64_tr_b16 v[20:21], v5 offset:0
    ds_read_b64_tr_b16 v[22:23], v5 offset:6144
    ds_read_b64_tr_b16 v[24:25], v6 offset:0
    ds_read_b64_tr_b16 v[26:27], v6 offset:6144
K2_GL:
    s_waitcnt lgkmcnt(4)
    v_mfma_f32_16x16x32_bf16 v[96:99], v[16:19], v[32:35], v[96:99]
    ds_read_b64_tr_b16 v[28:29], v7 offset:0
    v_mfma_f32_16x16x32_bf16 v[100:103], v[16:19], v[36:39], v[100:103]
    v_mfma_f32_16x16x32_bf16 v[104:107], v[16:19], v[40:43], v[104:107]
    ds_read_b64_tr_b16 v[30:31], v7 offset:6144
    v_mfma_f32_16x16x32_bf16 v[108:111], v[16:19], v[44:47], v[108:111]
    s_waitcnt lgkmcnt(4)
    v_mfma_f32_16x16x32_bf16 v[112:115], v[20:23], v[32:35], v[112:115]
    ds_read_b64_tr_b16 v[16:17], v4 offset:128
    v_mfma_f32_16x16x32_bf16 v[116:119], v[20:23], v[36:39], v[116:119]
    ds_read_b64_tr_b16 v[18:19], v4 offset:6272
    v_mfma_f32_16x16x32_bf16 v[120:123], v[20:23], v[40:43], v[120:123]
    ds_read_b128 v[48:51], v12 offset:8192
    v_mfma_f32_16x16x32_bf16 v[124:127], v[20:23], v[44:47], v[124:127]
    s_waitcnt lgkmcnt(5)
    v_mfma_f32_16x16x32_bf16 v[128:131], v[24:27], v[32:35], v[128:131]
    ds_read_b64_tr_b16 v[20:21], v5 offset:128
    v_mfma_f32_16x16x32_bf16 v[132:135], v[24:27], v[36:39], v[132:135]
    ds_read_b64_tr_b16 v[22:23], v5 offset:6272
    v_mfma_f32_16x16x32_bf16 v[136:139], v[24:27], v[40:43], v[136:139]
    ds_read_b128 v[52:55], v12 offset:9216
    v_mfma_f32_16x16x32_bf16 v[140:143], v[24:27], v[44:47], v[140:143]
    s_waitcnt lgkmcnt(6)
    v_mfma_f32_16x16x32_bf16 v[144:147], v[28:31], v[32:35], v[144:147]
    ds_read_b64_tr_b16 v[24:25], v4 offset:12288
    v_mfma_f32_16x16x32_bf16 v[148:151], v[28:31], v[36:39], v[148:151]
    ds_read_b64_tr_b16 v[26:27], v4 offset:18432
    v_mfma_f32_16x16x32_bf16 v[152:155], v[28:31], v[40:43], v[152:155]
    ds_read_b128 v[56:59], v12 offset:10240
    v_mfma_f32_16x16x32_bf16 v[156:159], v[28:31], v[44:47], v[156:159]
    s_waitcnt lgkmcnt(7)
    v_mfma_f32_16x16x32_bf16 v[160:163], v[16:19], v[32:35], v[160:163]
    ds_read_b64_tr_b16 v[28:29], v5 offset:12288
    v_mfma_f32_16x16x32_bf16 v[164:167], v[16:19], v[36:39], v[164:167]
    ds_read_b64_tr_b16 v[30:31], v5 offset:18432
    v_mfma_f32_16x16x32_bf16 v[168:171], v[16:19], v[40:43], v[168:171]
    ds_read_b128 v[60:63], v12 offset:11264
    v_mfma_f32_16x16x32_bf16 v[172:175], v[16:19], v[44:47], v[172:175]
    s_waitcnt lgkmcnt(7)
    v_mfma_f32_16x16x32_bf16 v[176:179], v[20:23], v[32:35], v[176:179]
    ds_read_b64_tr_b16 v[16:17], v6 offset:12288
    v_mfma_f32_16x16x32_bf16 v[180:183], v[20:23], v[36:39], v[180:183]
    v_mfma_f32_16x16x32_bf16 v[184:187], v[20:23], v[40:43], v[184:187]
    ds_read_b64_tr_b16 v[18:19], v6 offset:18432
    v_mfma_f32_16x16x32_bf16 v[188:191], v[20:23], v[44:47], v[188:191]
    s_waitcnt lgkmcnt(2)
    v_mfma_f32_16x16x32_bf16 v[96:99], v[24:27], v[48:51], v[96:99]
    ds_read_b64_tr_b16 v[20:21], v7 offset:12288
    v_mfma_f32_16x16x32_bf16 v[100:103], v[24:27], v[52:55], v[100:103]
    v_mfma_f32_16x16x32_bf16 v[104:107], v[24:27], v[56:59], v[104:107]
    ds_read_b64_tr_b16 v[22:23], v7 offset:18432
    v_mfma_f32_16x16x32_bf16 v[108:111], v[24:27], v[60:63], v[108:111]
    v_mfma_f32_16x16x32_bf16 v[112:115], v[28:31], v[48:51], v[112:115]
    ds_read_b64_tr_b16 v[24:25], v4 offset:12416
    v_mfma_f32_16x16x32_bf16 v[116:119], v[28:31], v[52:55], v[116:119]
    v_mfma_f32_16x16x32_bf16 v[120:123], v[28:31], v[56:59], v[120:123]
    ds_read_b64_tr_b16 v[26:27], v4 offset:18560
    v_mfma_f32_16x16x32_bf16 v[124:127], v[28:31], v[60:63], v[124:127]
    s_waitcnt lgkmcnt(4)
    v_mfma_f32_16x16x32_bf16 v[128:131], v[16:19], v[48:51], v[128:131]
    ds_read_b64_tr_b16 v[28:29], v5 offset:12416
    ds_read_b64_tr_b16 v[30:31], v5 offset:18560
    v_mfma_f32_16x16x32_bf16 v[132:135], v[16:19], v[52:55], v[132:135]
    s_add_u32 s44, s44, 40960
    s_cmp_ge_u32 s44, 163840
    s_cselect_b32 s44, 0, s44
    v_add_u32 v4, s44, v8
    v_mfma_f32_16x16x32_bf16 v[136:139], v[16:19], v[56:59], v[136:139]
    v_add_u32 v5, s44, v9
    v_add_u32 v6, s44, v10
    v_mfma_f32_16x16x32_bf16 v[140:143], v[16:19], v[60:63], v[140:143]
    v_add_u32 v7, s44, v11
    v_add_u32 v12, s44, v13
    s_barrier
    s_waitcnt lgkmcnt(4)
    v_mfma_f32_16x16x32_bf16 v[144:147], v[20:23], v[48:51], v[144:147]
    ds_read_b128 v[32:35], v12 offset:0
    v_mfma_f32_16x16x32_bf16 v[148:151], v[20:23], v[52:55], v[148:151]
    ds_read_b128 v[36:39], v12 offset:1024
    v_mfma_f32_16x16x32_bf16 v[152:155], v[20:23], v[56:59], v[152:155]
    ds_read_b64_tr_b16 v[16:17], v4 offset:0
    v_mfma_f32_16x16x32_bf16 v[156:159], v[20:23], v[60:63], v[156:159]
    ds_read_b64_tr_b16 v[18:19], v4 offset:6144
    s_waitcnt lgkmcnt(6)
    v_mfma_f32_16x16x32_bf16 v[160:163], v[24:27], v[48:51], v[160:163]
    ds_read_b128 v[40:43], v12 offset:2048
    v_mfma_f32_16x16x32_bf16 v[164:167], v[24:27], v[52:55], v[164:167]
    ds_read_b128 v[44:47], v12 offset:3072
    v_mfma_f32_16x16x32_bf16 v[168:171], v[24:27], v[56:59], v[168:171]
    ds_read_b64_tr_b16 v[20:21], v5 offset:0
    v_mfma_f32_16x16x32_bf16 v[172:175], v[24:27], v[60:63], v[172:175]
    ds_read_b64_tr_b16 v[22:23], v5 offset:6144
    s_waitcnt lgkmcnt(8)
    v_mfma_f32_16x16x32_bf16 v[176:179], v[28:31], v[48:51], v[176:179]
    ds_read_b64_tr_b16 v[24:25], v6 offset:0
    v_mfma_f32_16x16x32_bf16 v[180:183], v[28:31], v[52:55], v[180:183]
    v_mfma_f32_16x16x32_bf16 v[184:187], v[28:31], v[56:59], v[184:187]
    ds_read_b64_tr_b16 v[26:27], v6 offset:6144
    v_mfma_f32_16x16x32_bf16 v[188:191], v[28:31], v[60:63], v[188:191]
    s_cmp_lg_u32 s43, 14
    s_cbranch_scc1 K2_GL1
    buffer_store_dwordx4 v[224:227], v2, s[24:27], s4 offen offset:1024 sc1
    buffer_store_dwordx4 v[228:231], v2, s[24:27], s5 offen offset:1024 sc1
    buffer_store_dwordx4 v[232:235], v2, s[24:27], s6 offen offset:1024 sc1
    buffer_store_dwordx4 v[236:239], v2, s[24:27], s7 offen offset:1024 sc1
    buffer_store_dwordx2 v[240:241], v220, s[24:27], s8 offen sc1
    buffer_store_dwordx2 v[244:245], v220, s[24:27], s9 offen sc1
    buffer_store_dwordx2 v[248:249], v220, s[24:27], s10 offen sc1
    buffer_store_dwordx2 v[252:253], v220, s[24:27], s11 offen sc1
K2_GL1:
    s_cmp_lg_u32 s43, 12
    s_cbranch_scc1 K2_GL2
    s_waitcnt vmcnt(0)
    v_mov_b32 v14, s62
    v_mov_b32 v15, 0
    s_mov_b64 exec, 1
    buffer_store_dword v14, v15, s[24:27], s63 offen sc1
    s_mov_b64 exec, -1
    s_add_u32 s63, s63, 8192
    v_mov_b32 v216, s62
    v_mov_b32 v217, 0
    s_mov_b64 exec, 1
    buffer_store_dword v216, v217, s[24:27], s63 offen sc1
    s_mov_b64 exec, -1
K2_GL2:
    s_sub_u32 s43, s43, 1
    s_cmp_lg_u32 s43, 11
    s_cbranch_scc1 K2_GL
K2_GM:
    s_waitcnt lgkmcnt(4)
    v_mfma_f32_16x16x32_bf16 v[96:99], v[16:19], v[32:35], v[96:99]
    ds_read_b64_tr_b16 v[28:29], v7 offset:0
    v_mfma_f32_16x16x32_bf16 v[100:103], v[16:19], v[36:39], v[100:103]
    v_mfma_f32_16x16x32_bf16 v[104:107], v[16:19], v[40:43], v[104:107]
    ds_read_b64_tr_b16 v[30:31], v7 offset:6144
    v_mfma_f32_16x16x32_bf16 v[108:111], v[16:19], v[44:47], v[108:111]
    s_waitcnt lgkmcnt(4)
    v_mfma_f32_16x16x32_bf16 v[112:115], v[20:23], v[32:35], v[112:115]
    ds_read_b64_tr_b16 v[16:17], v4 offset:128
    v_mfma_f32_16x16x32_bf16 v[116:119], v[20:23], v[36:39], v[116:119]
    ds_read_b64_tr_b16 v[18:19], v4 offset:6272
    v_mfma_f32_16x16x32_bf16 v[120:123], v[20:23], v[40:43], v[120:123]
    ds_read_b128 v[48:51], v12 offset:8192
    v_mfma_f32_16x16x32_bf16 v[124:127], v[20:23], v[44:47], v[124:127]
    s_waitcnt lgkmcnt(5)
    v_mfma_f32_16x16x32_bf16 v[128:131], v[24:27], v[32:35], v[128:131]
    ds_read_b64_tr_b16 v[20:21], v5 offset:128
    v_mfma_f32_16x16x32_bf16 v[132:135], v[24:27], v[36:39], v[132:135]
    ds_read_b64_tr_b16 v[22:23], v5 offset:6272
    v_mfma_f32_16x16x32_bf16 v[136:139], v[24:27], v[40:43], v[136:139]
    ds_read_b128 v[52:55], v12 offset:9216
    v_mfma_f32_16x16x32_bf16 v[140:143], v[24:27], v[44:47], v[140:143]
    s_waitcnt lgkmcnt(6)
    v_mfma_f32_16x16x32_bf16 v[144:147], v[28:31], v[32:35], v[144:147]
    ds_read_b64_tr_b16 v[24:25], v4 offset:12288
    v_mfma_f32_16x16x32_bf16 v[148:151], v[28:31], v[36:39], v[148:151]
    ds_read_b64_tr_b16 v[26:27], v4 offset:18432
    v_mfma_f32_16x16x32_bf16 v[152:155], v[28:31], v[40:43], v[152:155]
    ds_read_b128 v[56:59], v12 offset:10240
    v_mfma_f32_16x16x32_bf16 v[156:159], v[28:31], v[44:47], v[156:159]
    s_waitcnt lgkmcnt(7)
    v_mfma_f32_16x16x32_bf16 v[160:163], v[16:19], v[32:35], v[160:163]
    ds_read_b64_tr_b16 v[28:29], v5 offset:12288
    v_mfma_f32_16x16x32_bf16 v[164:167], v[16:19], v[36:39], v[164:167]
    ds_read_b64_tr_b16 v[30:31], v5 offset:18432
    v_mfma_f32_16x16x32_bf16 v[168:171], v[16:19], v[40:43], v[168:171]
    ds_read_b128 v[60:63], v12 offset:11264
    v_mfma_f32_16x16x32_bf16 v[172:175], v[16:19], v[44:47], v[172:175]
    s_waitcnt lgkmcnt(7)
    v_mfma_f32_16x16x32_bf16 v[176:179], v[20:23], v[32:35], v[176:179]
    ds_read_b64_tr_b16 v[16:17], v6 offset:12288
    v_mfma_f32_16x16x32_bf16 v[180:183], v[20:23], v[36:39], v[180:183]
    v_mfma_f32_16x16x32_bf16 v[184:187], v[20:23], v[40:43], v[184:187]
    ds_read_b64_tr_b16 v[18:19], v6 offset:18432
    v_mfma_f32_16x16x32_bf16 v[188:191], v[20:23], v[44:47], v[188:191]
    s_waitcnt lgkmcnt(2)
    v_mfma_f32_16x16x32_bf16 v[96:99], v[24:27], v[48:51], v[96:99]
    ds_read_b64_tr_b16 v[20:21], v7 offset:12288
    v_mfma_f32_16x16x32_bf16 v[100:103], v[24:27], v[52:55], v[100:103]
    v_mfma_f32_16x16x32_bf16 v[104:107], v[24:27], v[56:59], v[104:107]
    ds_read_b64_tr_b16 v[22:23], v7 offset:18432
    v_mfma_f32_16x16x32_bf16 v[108:111], v[24:27], v[60:63], v[108:111]
    v_mfma_f32_16x16x32_bf16 v[112:115], v[28:31], v[48:51], v[112:115]
    ds_read_b64_tr_b16 v[24:25], v4 offset:12416
    v_mfma_f32_16x16x32_bf16 v[116:119], v[28:31], v[52:55], v[116:119]
    v_mfma_f32_16x16x32_bf16 v[120:123], v[28:31], v[56:59], v[120:123]
    ds_read_b64_tr_b16 v[26:27], v4 offset:18560
    v_mfma_f32_16x16x32_bf16 v[124:127], v[28:31], v[60:63], v[124:127]
    s_waitcnt lgkmcnt(4)
    v_mfma_f32_16x16x32_bf16 v[128:131], v[16:19], v[48:51], v[128:131]
    ds_read_b64_tr_b16 v[28:29], v5 offset:12416
    ds_read_b64_tr_b16 v[30:31], v5 offset:18560
    v_mfma_f32_16x16x32_bf16 v[132:135], v[16:19], v[52:55], v[132:135]
    s_add_u32 s44, s44, 40960
    s_cmp_ge_u32 s44, 163840
    s_cselect_b32 s44, 0, s44
    v_add_u32 v4, s44, v8
    v_mfma_f32_16x16x32_bf16 v[136:139], v[16:19], v[56:59], v[136:139]
    v_add_u32 v5, s44, v9
    v_add_u32 v6, s44, v10
    v_mfma_f32_16x16x32_bf16 v[140:143], v[16:19], v[60:63], v[140:143]
    v_add_u32 v7, s44, v11
    v_add_u32 v12, s44, v13
    s_barrier
    s_waitcnt lgkmcnt(4)
    v_mfma_f32_16x16x32_bf16 v[144:147], v[20:23], v[48:51], v[144:147]
    ds_read_b128 v[32:35], v12 offset:0
    v_mfma_f32_16x16x32_bf16 v[148:151], v[20:23], v[52:55], v[148:151]
    ds_read_b128 v[36:39], v12 offset:1024
    v_mfma_f32_16x16x32_bf16 v[152:155], v[20:23], v[56:59], v[152:155]
    ds_read_b64_tr_b16 v[16:17], v4 offset:0
    v_mfma_f32_16x16x32_bf16 v[156:159], v[20:23], v[60:63], v[156:159]
    ds_read_b64_tr_b16 v[18:19], v4 offset:6144
    s_waitcnt lgkmcnt(6)
    v_mfma_f32_16x16x32_bf16 v[160:163], v[24:27], v[48:51], v[160:163]
    ds_read_b128 v[40:43], v12 offset:2048
    v_mfma_f32_16x16x32_bf16 v[164:167], v[24:27], v[52:55], v[164:167]
    ds_read_b128 v[44:47], v12 offset:3072
    v_mfma_f32_16x16x32_bf16 v[168:171], v[24:27], v[56:59], v[168:171]
    ds_read_b64_tr_b16 v[20:21], v5 offset:0
    v_mfma_f32_16x16x32_bf16 v[172:175], v[24:27], v[60:63], v[172:175]
    ds_read_b64_tr_b16 v[22:23], v5 offset:6144
    s_waitcnt lgkmcnt(8)
    v_mfma_f32_16x16x32_bf16 v[176:179], v[28:31], v[48:51], v[176:179]
    ds_read_b64_tr_b16 v[24:25], v6 offset:0
    v_mfma_f32_16x16x32_bf16 v[180:183], v[28:31], v[52:55], v[180:183]
    v_mfma_f32_16x16x32_bf16 v[184:187], v[28:31], v[56:59], v[184:187]
    ds_read_b64_tr_b16 v[26:27], v6 offset:6144
    v_mfma_f32_16x16x32_bf16 v[188:191], v[28:31], v[60:63], v[188:191]
    s_sub_u32 s43, s43, 1
    s_cmp_lg_u32 s43, 0
    s_cbranch_scc1 K2_GM
    v_lshlrev_b32 v15, 3, v1
    s_waitcnt lgkmcnt(4)
    v_mfma_f32_16x16x32_bf16 v[96:99], v[16:19], v[32:35], v[96:99]
    ds_read_b64_tr_b16 v[28:29], v7 offset:0
    v_mfma_f32_16x16x32_bf16 v[100:103], v[16:19], v[36:39], v[100:103]
    v_mfma_f32_16x16x32_bf16 v[104:107], v[16:19], v[40:43], v[104:107]
    ds_read_b64_tr_b16 v[30:31], v7 offset:6144
    v_mfma_f32_16x16x32_bf16 v[108:111], v[16:19], v[44:47], v[108:111]
    s_waitcnt lgkmcnt(4)
    v_mfma_f32_16x16x32_bf16 v[112:115], v[20:23], v[32:35], v[112:115]
    ds_read_b64_tr_b16 v[16:17], v4 offset:128
    v_mfma_f32_16x16x32_bf16 v[116:119], v[20:23], v[36:39], v[116:119]
    ds_read_b64_tr_b16 v[18:19], v4 offset:6272
    v_mfma_f32_16x16x32_bf16 v[120:123], v[20:23], v[40:43], v[120:123]
    ds_read_b128 v[48:51], v12 offset:8192
    v_mfma_f32_16x16x32_bf16 v[124:127], v[20:23], v[44:47], v[124:127]
    s_waitcnt lgkmcnt(5)
    v_mfma_f32_16x16x32_bf16 v[128:131], v[24:27], v[32:35], v[128:131]
    ds_read_b64_tr_b16 v[20:21], v5 offset:128
    v_mfma_f32_16x16x32_bf16 v[132:135], v[24:27], v[36:39], v[132:135]
    ds_read_b64_tr_b16 v[22:23], v5 offset:6272
    v_mfma_f32_16x16x32_bf16 v[136:139], v[24:27], v[40:43], v[136:139]
    ds_read_b128 v[52:55], v12 offset:9216
    v_mfma_f32_16x16x32_bf16 v[140:143], v[24:27], v[44:47], v[140:143]
    s_waitcnt lgkmcnt(6)
    v_mfma_f32_16x16x32_bf16 v[144:147], v[28:31], v[32:35], v[144:147]
    ds_read_b64_tr_b16 v[24:25], v4 offset:12288
    v_mfma_f32_16x16x32_bf16 v[148:151], v[28:31], v[36:39], v[148:151]
    ds_read_b64_tr_b16 v[26:27], v4 offset:18432
    v_mfma_f32_16x16x32_bf16 v[152:155], v[28:31], v[40:43], v[152:155]
    ds_read_b128 v[56:59], v12 offset:10240
    v_mfma_f32_16x16x32_bf16 v[156:159], v[28:31], v[44:47], v[156:159]
    s_waitcnt lgkmcnt(7)
    v_mfma_f32_16x16x32_bf16 v[160:163], v[16:19], v[32:35], v[160:163]
    ds_read_b64_tr_b16 v[28:29], v5 offset:12288
    v_mfma_f32_16x16x32_bf16 v[164:167], v[16:19], v[36:39], v[164:167]
    ds_read_b64_tr_b16 v[30:31], v5 offset:18432
    v_mfma_f32_16x16x32_bf16 v[168:171], v[16:19], v[40:43], v[168:171]
    ds_read_b128 v[60:63], v12 offset:11264
    v_mfma_f32_16x16x32_bf16 v[172:175], v[16:19], v[44:47], v[172:175]
    s_waitcnt lgkmcnt(7)
    v_mfma_f32_16x16x32_bf16 v[176:179], v[20:23], v[32:35], v[176:179]
    ds_read_b64_tr_b16 v[16:17], v6 offset:12288
    v_mfma_f32_16x16x32_bf16 v[180:183], v[20:23], v[36:39], v[180:183]
    v_mfma_f32_16x16x32_bf16 v[184:187], v[20:23], v[40:43], v[184:187]
    ds_read_b64_tr_b16 v[18:19], v6 offset:18432
    v_mfma_f32_16x16x32_bf16 v[188:191], v[20:23], v[44:47], v[188:191]
    s_waitcnt lgkmcnt(2)
    v_mfma_f32_16x16x32_bf16 v[96:99], v[24:27], v[48:51], v[96:99]
    ds_read_b64_tr_b16 v[20:21], v7 offset:12288
    v_mfma_f32_16x16x32_bf16 v[100:103], v[24:27], v[52:55], v[100:103]
    v_mfma_f32_16x16x32_bf16 v[104:107], v[24:27], v[56:59], v[104:107]
    ds_read_b64_tr_b16 v[22:23], v7 offset:18432
    v_mfma_f32_16x16x32_bf16 v[108:111], v[24:27], v[60:63], v[108:111]
    v_mfma_f32_16x16x32_bf16 v[112:115], v[28:31], v[48:51], v[112:115]
    ds_read_b64_tr_b16 v[24:25], v4 offset:12416
    v_mfma_f32_16x16x32_bf16 v[116:119], v[28:31], v[52:55], v[116:119]
    v_mfma_f32_16x16x32_bf16 v[120:123], v[28:31], v[56:59], v[120:123]
    ds_read_b64_tr_b16 v[26:27], v4 offset:18560
    v_mfma_f32_16x16x32_bf16 v[124:127], v[28:31], v[60:63], v[124:127]
    s_waitcnt lgkmcnt(4)
    v_mfma_f32_16x16x32_bf16 v[128:131], v[16:19], v[48:51], v[128:131]
    ds_read_b64_tr_b16 v[28:29], v5 offset:12416
    ds_read_b64_tr_b16 v[30:31], v5 offset:18560
    s_add_u32 s44, s44, 40960
    s_cmp_ge_u32 s44, 163840
    s_cselect_b32 s44, 0, s44
    v_mfma_f32_16x16x32_bf16 v[132:135], v[16:19], v[52:55], v[132:135]
    v_add_u32 v4, s44, v8
    v_add_u32 v5, s44, v9
    v_mfma_f32_16x16x32_bf16 v[136:139], v[16:19], v[56:59], v[136:139]
    v_add_u32 v6, s44, v10
    v_add_u32 v7, s44, v11
    v_mfma_f32_16x16x32_bf16 v[140:143], v[16:19], v[60:63], v[140:143]
    v_add_u32 v12, s44, v13
    v_sub_u32 v14, v12, v15
    s_barrier
    s_waitcnt lgkmcnt(4)
    v_mfma_f32_16x16x32_bf16 v[144:147], v[20:23], v[48:51], v[144:147]
    ds_read_b64 v[32:33], v14 offset:0
    ds_read_b64 v[34:35], v14 offset:512
    v_mfma_f32_16x16x32_bf16 v[148:151], v[20:23], v[52:55], v[148:151]
    ds_read_b64 v[36:37], v14 offset:1024
    v_mfma_f32_16x16x32_bf16 v[152:155], v[20:23], v[56:59], v[152:155]
    ds_read_b64 v[38:39], v14 offset:1536
    ds_read_b64_tr_b16 v[16:17], v4 offset:0
    v_mfma_f32_16x16x32_bf16 v[156:159], v[20:23], v[60:63], v[156:159]
    ds_read_b64_tr_b16 v[18:19], v4 offset:6144
    s_waitcnt lgkmcnt(8)
    v_mfma_f32_16x16x32_bf16 v[160:163], v[24:27], v[48:51], v[160:163]
    ds_read_b64 v[40:41], v14 offset:2048
    ds_read_b64 v[42:43], v14 offset:2560
    v_mfma_f32_16x16x32_bf16 v[164:167], v[24:27], v[52:55], v[164:167]
    ds_read_b64 v[44:45], v14 offset:3072
    v_mfma_f32_16x16x32_bf16 v[168:171], v[24:27], v[56:59], v[168:171]
    ds_read_b64 v[46:47], v14 offset:3584
    ds_read_b64_tr_b16 v[20:21], v5 offset:0
    v_mfma_f32_16x16x32_bf16 v[172:175], v[24:27], v[60:63], v[172:175]
    ds_read_b64_tr_b16 v[22:23], v5 offset:6144
    s_waitcnt lgkmcnt(12)
    v_mfma_f32_16x16x32_bf16 v[176:179], v[28:31], v[48:51], v[176:179]
    ds_read_b64_tr_b16 v[24:25], v6 offset:0
    v_mfma_f32_16x16x32_bf16 v[180:183], v[28:31], v[52:55], v[180:183]
    v_mfma_f32_16x16x32_bf16 v[184:187], v[28:31], v[56:59], v[184:187]
    ds_read_b64_tr_b16 v[26:27], v6 offset:6144
    v_mfma_f32_16x16x32_bf16 v[188:191], v[28:31], v[60:63], v[188:191]
    s_waitcnt lgkmcnt(4)
    v_mfma_f32_16x16x32_bf16 v[96:99], v[16:19], v[32:35], v[96:99]
    ds_read_b64_tr_b16 v[28:29], v7 offset:0
    v_mfma_f32_16x16x32_bf16 v[100:103], v[16:19], v[36:39], v[100:103]
    v_mfma_f32_16x16x32_bf16 v[104:107], v[16:19], v[40:43], v[104:107]
    ds_read_b64_tr_b16 v[30:31], v7 offset:6144
    v_mfma_f32_16x16x32_bf16 v[108:111], v[16:19], v[44:47], v[108:111]
    s_waitcnt lgkmcnt(4)
    v_mfma_f32_16x16x32_bf16 v[112:115], v[20:23], v[32:35], v[112:115]
    ds_read_b64_tr_b16 v[16:17], v4 offset:128
    v_mfma_f32_16x16x32_bf16 v[116:119], v[20:23], v[36:39], v[116:119]
    ds_read_b64_tr_b16 v[18:19], v4 offset:6272
    v_mfma_f32_16x16x32_bf16 v[120:123], v[20:23], v[40:43], v[120:123]
    ds_read_b64 v[48:49], v14 offset:8192
    v_mfma_f32_16x16x32_bf16 v[124:127], v[20:23], v[44:47], v[124:127]
    ds_read_b64 v[50:51], v14 offset:8704
    s_waitcnt lgkmcnt(6)
    v_mfma_f32_16x16x32_bf16 v[128:131], v[24:27], v[32:35], v[128:131]
    ds_read_b64_tr_b16 v[20:21], v5 offset:128
    v_mfma_f32_16x16x32_bf16 v[132:135], v[24:27], v[36:39], v[132:135]
    ds_read_b64_tr_b16 v[22:23], v5 offset:6272
    v_mfma_f32_16x16x32_bf16 v[136:139], v[24:27], v[40:43], v[136:139]
    ds_read_b64 v[52:53], v14 offset:9216
    v_mfma_f32_16x16x32_bf16 v[140:143], v[24:27], v[44:47], v[140:143]
    ds_read_b64 v[54:55], v14 offset:9728
    s_waitcnt lgkmcnt(8)
    v_mfma_f32_16x16x32_bf16 v[144:147], v[28:31], v[32:35], v[144:147]
    ds_read_b64_tr_b16 v[24:25], v4 offset:12288
    v_mfma_f32_16x16x32_bf16 v[148:151], v[28:31], v[36:39], v[148:151]
    ds_read_b64_tr_b16 v[26:27], v4 offset:18432
    v_mfma_f32_16x16x32_bf16 v[152:155], v[28:31], v[40:43], v[152:155]
    ds_read_b64 v[56:57], v14 offset:10240
    v_mfma_f32_16x16x32_bf16 v[156:159], v[28:31], v[44:47], v[156:159]
    ds_read_b64 v[58:59], v14 offset:10752
    s_waitcnt lgkmcnt(10)
    v_mfma_f32_16x16x32_bf16 v[160:163], v[16:19], v[32:35], v[160:163]
    ds_read_b64_tr_b16 v[28:29], v5 offset:12288
    v_mfma_f32_16x16x32_bf16 v[164:167], v[16:19], v[36:39], v[164:167]
    ds_read_b64_tr_b16 v[30:31], v5 offset:18432
    v_mfma_f32_16x16x32_bf16 v[168:171], v[16:19], v[40:43], v[168:171]
    ds_read_b64 v[60:61], v14 offset:11264
    v_mfma_f32_16x16x32_bf16 v[172:175], v[16:19], v[44:47], v[172:175]
    ds_read_b64 v[62:63], v14 offset:11776
    s_waitcnt lgkmcnt(10)
    v_mfma_f32_16x16x32_bf16 v[176:179], v[20:23], v[32:35], v[176:179]
    ds_read_b64_tr_b16 v[16:17], v6 offset:12288
    v_mfma_f32_16x16x32_bf16 v[180:183], v[20:23], v[36:39], v[180:183]
    v_mfma_f32_16x16x32_bf16 v[184:187], v[20:23], v[40:43], v[184:187]
    ds_read_b64_tr_b16 v[18:19], v6 offset:18432
    v_mfma_f32_16x16x32_bf16 v[188:191], v[20:23], v[44:47], v[188:191]
    s_waitcnt lgkmcnt(2)
    v_mfma_f32_16x16x32_bf16 v[96:99], v[24:27], v[48:51], v[96:99]
    ds_read_b64_tr_b16 v[20:21], v7 offset:12288
    v_mfma_f32_16x16x32_bf16 v[100:103], v[24:27], v[52:55], v[100:103]
    v_mfma_f32_16x16x32_bf16 v[104:107], v[24:27], v[56:59], v[104:107]
    ds_read_b64_tr_b16 v[22:23], v7 offset:18432
    v_mfma_f32_16x16x32_bf16 v[108:111], v[24:27], v[60:63], v[108:111]
    v_mfma_f32_16x16x32_bf16 v[112:115], v[28:31], v[48:51], v[112:115]
    ds_read_b64_tr_b16 v[24:25], v4 offset:12416
    v_mfma_f32_16x16x32_bf16 v[116:119], v[28:31], v[52:55], v[116:119]
    v_mfma_f32_16x16x32_bf16 v[120:123], v[28:31], v[56:59], v[120:123]
    ds_read_b64_tr_b16 v[26:27], v4 offset:18560
    v_mfma_f32_16x16x32_bf16 v[124:127], v[28:31], v[60:63], v[124:127]
    s_waitcnt lgkmcnt(4)
    v_mfma_f32_16x16x32_bf16 v[128:131], v[16:19], v[48:51], v[128:131]
    ds_read_b64_tr_b16 v[28:29], v5 offset:12416
    ds_read_b64_tr_b16 v[30:31], v5 offset:18560
    s_add_u32 s44, s44, 40960
    s_cmp_ge_u32 s44, 163840
    s_cselect_b32 s44, 0, s44
    v_mfma_f32_16x16x32_bf16 v[132:135], v[16:19], v[52:55], v[132:135]
    v_add_u32 v4, s44, v8
    v_add_u32 v5, s44, v9
    v_mfma_f32_16x16x32_bf16 v[136:139], v[16:19], v[56:59], v[136:139]
    v_add_u32 v6, s44, v10
    v_add_u32 v7, s44, v11
    v_mfma_f32_16x16x32_bf16 v[140:143], v[16:19], v[60:63], v[140:143]
    v_add_u32 v12, s44, v13
    v_sub_u32 v14, v12, v15
    s_barrier
    s_waitcnt lgkmcnt(4)
    v_mfma_f32_16x16x32_bf16 v[144:147], v[20:23], v[48:51], v[144:147]
    ds_read_b64 v[32:33], v14 offset:0
    ds_read_b64 v[34:35], v14 offset:512
    v_mfma_f32_16x16x32_bf16 v[148:151], v[20:23], v[52:55], v[148:151]
    ds_read_b64 v[36:37], v14 offset:1024
    v_mfma_f32_16x16x32_bf16 v[152:155], v[20:23], v[56:59], v[152:155]
    ds_read_b64 v[38:39], v14 offset:1536
    ds_read_b64_tr_b16 v[16:17], v4 offset:0
    v_mfma_f32_16x16x32_bf16 v[156:159], v[20:23], v[60:63], v[156:159]
    ds_read_b64_tr_b16 v[18:19], v4 offset:6144
    s_waitcnt lgkmcnt(8)
    v_mfma_f32_16x16x32_bf16 v[160:163], v[24:27], v[48:51], v[160:163]
    ds_read_b64 v[40:41], v14 offset:2048
    ds_read_b64 v[42:43], v14 offset:2560
    v_mfma_f32_16x16x32_bf16 v[164:167], v[24:27], v[52:55], v[164:167]
    ds_read_b64 v[44:45], v14 offset:3072
    v_mfma_f32_16x16x32_bf16 v[168:171], v[24:27], v[56:59], v[168:171]
    ds_read_b64 v[46:47], v14 offset:3584
    ds_read_b64_tr_b16 v[20:21], v5 offset:0
    v_mfma_f32_16x16x32_bf16 v[172:175], v[24:27], v[60:63], v[172:175]
    ds_read_b64_tr_b16 v[22:23], v5 offset:6144
    s_waitcnt lgkmcnt(12)
    v_mfma_f32_16x16x32_bf16 v[176:179], v[28:31], v[48:51], v[176:179]
    ds_read_b64_tr_b16 v[24:25], v6 offset:0
    v_mfma_f32_16x16x32_bf16 v[180:183], v[28:31], v[52:55], v[180:183]
    v_mfma_f32_16x16x32_bf16 v[184:187], v[28:31], v[56:59], v[184:187]
    ds_read_b64_tr_b16 v[26:27], v6 offset:6144
    v_mfma_f32_16x16x32_bf16 v[188:191], v[28:31], v[60:63], v[188:191]
    s_waitcnt lgkmcnt(4)
    v_mfma_f32_16x16x32_bf16 v[96:99], v[16:19], v[32:35], v[96:99]
    ds_read_b64_tr_b16 v[28:29], v7 offset:0
    ds_read_b64_tr_b16 v[30:31], v7 offset:6144
    v_mfma_f32_16x16x32_bf16 v[100:103], v[16:19], v[36:39], v[100:103]
    buffer_load_dword v212, v215, s[24:27], s61 offen offset:0 sc1
    v_mfma_f32_16x16x32_bf16 v[104:107], v[16:19], v[40:43], v[104:107]
    buffer_load_dword v213, v215, s[24:27], s61 offen offset:64 sc1
    buffer_load_dword v214, v215, s[24:27], s61 offen offset:128 sc1
    v_mfma_f32_16x16x32_bf16 v[108:111], v[16:19], v[44:47], v[108:111]
    buffer_load_dword v215, v215, s[24:27], s61 offen offset:192 sc1
    s_waitcnt lgkmcnt(4)
    v_mfma_f32_16x16x32_bf16 v[112:115], v[20:23], v[32:35], v[112:115]
    ds_read_b64_tr_b16 v[16:17], v4 offset:128
    v_mfma_f32_16x16x32_bf16 v[116:119], v[20:23], v[36:39], v[116:119]
    ds_read_b64_tr_b16 v[18:19], v4 offset:6272
    v_mfma_f32_16x16x32_bf16 v[120:123], v[20:23], v[40:43], v[120:123]
    ds_read_b64 v[48:49], v14 offset:8192
    v_mfma_f32_16x16x32_bf16 v[124:127], v[20:23], v[44:47], v[124:127]
    ds_read_b64 v[50:51], v14 offset:8704
    s_waitcnt lgkmcnt(6)
    v_mfma_f32_16x16x32_bf16 v[128:131], v[24:27], v[32:35], v[128:131]
    ds_read_b64_tr_b16 v[20:21], v5 offset:128
    v_mfma_f32_16x16x32_bf16 v[132:135], v[24:27], v[36:39], v[132:135]
    ds_read_b64_tr_b16 v[22:23], v5 offset:6272
    v_mfma_f32_16x16x32_bf16 v[136:139], v[24:27], v[40:43], v[136:139]
    ds_read_b64 v[52:53], v14 offset:9216
    v_mfma_f32_16x16x32_bf16 v[140:143], v[24:27], v[44:47], v[140:143]
    ds_read_b64 v[54:55], v14 offset:9728
    s_waitcnt lgkmcnt(8)
    v_mfma_f32_16x16x32_bf16 v[144:147], v[28:31], v[32:35], v[144:147]
    ds_read_b64_tr_b16 v[24:25], v4 offset:12288
    v_mfma_f32_16x16x32_bf16 v[148:151], v[28:31], v[36:39], v[148:151]
    ds_read_b64_tr_b16 v[26:27], v4 offset:18432
    v_mfma_f32_16x16x32_bf16 v[152:155], v[28:31], v[40:43], v[152:155]
    ds_read_b64 v[56:57], v14 offset:10240
    v_mfma_f32_16x16x32_bf16 v[156:159], v[28:31], v[44:47], v[156:159]
    ds_read_b64 v[58:59], v14 offset:10752
    s_waitcnt lgkmcnt(10)
    v_mfma_f32_16x16x32_bf16 v[160:163], v[16:19], v[32:35], v[160:163]
    ds_read_b64_tr_b16 v[28:29], v5 offset:12288
    v_mfma_f32_16x16x32_bf16 v[164:167], v[16:19], v[36:39], v[164:167]
    ds_read_b64_tr_b16 v[30:31], v5 offset:18432
    v_mfma_f32_16x16x32_bf16 v[168:171], v[16:19], v[40:43], v[168:171]
    ds_read_b64 v[60:61], v14 offset:11264
    v_mfma_f32_16x16x32_bf16 v[172:175], v[16:19], v[44:47], v[172:175]
    ds_read_b64 v[62:63], v14 offset:11776
    s_waitcnt lgkmcnt(10)
    v_mfma_f32_16x16x32_bf16 v[176:179], v[20:23], v[32:35], v[176:179]
    ds_read_b64_tr_b16 v[16:17], v6 offset:12288
    v_mfma_f32_16x16x32_bf16 v[180:183], v[20:23], v[36:39], v[180:183]
    v_mfma_f32_16x16x32_bf16 v[184:187], v[20:23], v[40:43], v[184:187]
    ds_read_b64_tr_b16 v[18:19], v6 offset:18432
    v_mfma_f32_16x16x32_bf16 v[188:191], v[20:23], v[44:47], v[188:191]
    s_waitcnt lgkmcnt(2)
    v_mfma_f32_16x16x32_bf16 v[96:99], v[24:27], v[48:51], v[96:99]
    ds_read_b64_tr_b16 v[20:21], v7 offset:12288
    v_mfma_f32_16x16x32_bf16 v[100:103], v[24:27], v[52:55], v[100:103]
    v_mfma_f32_16x16x32_bf16 v[104:107], v[24:27], v[56:59], v[104:107]
    ds_read_b64_tr_b16 v[22:23], v7 offset:18432
    v_mfma_f32_16x16x32_bf16 v[108:111], v[24:27], v[60:63], v[108:111]
    v_mfma_f32_16x16x32_bf16 v[112:115], v[28:31], v[48:51], v[112:115]
    ds_read_b64_tr_b16 v[24:25], v4 offset:12416
    v_mfma_f32_16x16x32_bf16 v[116:119], v[28:31], v[52:55], v[116:119]
    v_mfma_f32_16x16x32_bf16 v[120:123], v[28:31], v[56:59], v[120:123]
    ds_read_b64_tr_b16 v[26:27], v4 offset:18560
    v_mfma_f32_16x16x32_bf16 v[124:127], v[28:31], v[60:63], v[124:127]
    s_waitcnt lgkmcnt(4)
    v_mfma_f32_16x16x32_bf16 v[128:131], v[16:19], v[48:51], v[128:131]
    s_waitcnt vmcnt(0)
    v_mul_f32 v96, v212, v96
    v_mul_f32 v97, v212, v97
    ds_read_b64_tr_b16 v[28:29], v5 offset:12416
    v_mul_f32 v98, v212, v98
    v_mul_f32 v99, v212, v99
    ds_read_b64_tr_b16 v[30:31], v5 offset:18560
    v_mfma_f32_16x16x32_bf16 v[132:135], v[16:19], v[52:55], v[132:135]
    v_mul_f32 v100, v213, v100
    v_mul_f32 v101, v213, v101
    s_add_u32 s44, s44, 40960
    s_cmp_ge_u32 s44, 163840
    s_cselect_b32 s44, 0, s44
    v_mul_f32 v102, v213, v102
    v_mul_f32 v103, v213, v103
    v_add_u32 v4, s44, v8
    v_mfma_f32_16x16x32_bf16 v[136:139], v[16:19], v[56:59], v[136:139]
    v_mul_f32 v104, v214, v104
    v_add_u32 v5, s44, v9
    v_mul_f32 v105, v214, v105
    v_mul_f32 v106, v214, v106
    v_add_u32 v6, s44, v10
    v_mul_f32 v107, v214, v107
    v_mfma_f32_16x16x32_bf16 v[140:143], v[16:19], v[60:63], v[140:143]
    v_mul_f32 v108, v215, v108
    v_add_u32 v7, s44, v11
    v_mul_f32 v109, v215, v109
    v_mul_f32 v110, v215, v110
    v_add_u32 v12, s44, v13
    v_mul_f32 v111, v215, v111
    s_barrier
    s_waitcnt lgkmcnt(4)
    v_mfma_f32_16x16x32_bf16 v[144:147], v[20:23], v[48:51], v[144:147]
    ds_read_b64_tr_b16 v[32:33], v208 offset:0
    v_mul_f32 v112, v212, v112
    v_mul_f32 v113, v212, v113
    v_mul_f32 v114, v212, v114
    ds_read_b64_tr_b16 v[34:35], v208 offset:4096
    v_mul_f32 v115, v212, v115
    v_mfma_f32_16x16x32_bf16 v[148:151], v[20:23], v[52:55], v[148:151]
    v_mul_f32 v116, v213, v116
    v_mul_f32 v117, v213, v117
    ds_read_b64_tr_b16 v[36:37], v209 offset:0
    v_mul_f32 v118, v213, v118
    v_mul_f32 v119, v213, v119
    v_mfma_f32_16x16x32_bf16 v[152:155], v[20:23], v[56:59], v[152:155]
    ds_read_b64_tr_b16 v[38:39], v209 offset:4096
    v_mul_f32 v120, v214, v120
    v_mul_f32 v121, v214, v121
    v_mul_f32 v122, v214, v122
    ds_read_b64_tr_b16 v[16:17], v4 offset:0
    v_mul_f32 v123, v214, v123
    v_mfma_f32_16x16x32_bf16 v[156:159], v[20:23], v[60:63], v[156:159]
    v_mul_f32 v124, v215, v124
    v_mul_f32 v125, v215, v125
    ds_read_b64_tr_b16 v[18:19], v4 offset:6144
    v_mul_f32 v126, v215, v126
    v_mul_f32 v127, v215, v127
    s_waitcnt lgkmcnt(8)
    v_mfma_f32_16x16x32_bf16 v[160:163], v[24:27], v[48:51], v[160:163]
    ds_read_b64_tr_b16 v[40:41], v210 offset:0
    v_mul_f32 v128, v212, v128
    v_mul_f32 v129, v212, v129
    v_mul_f32 v130, v212, v130
    ds_read_b64_tr_b16 v[42:43], v210 offset:4096
    v_mul_f32 v131, v212, v131
    v_mfma_f32_16x16x32_bf16 v[164:167], v[24:27], v[52:55], v[164:167]
    v_mul_f32 v132, v213, v132
    v_mul_f32 v133, v213, v133
    ds_read_b64_tr_b16 v[44:45], v211 offset:0
    v_mul_f32 v134, v213, v134
    v_mul_f32 v135, v213, v135
    v_mfma_f32_16x16x32_bf16 v[168:171], v[24:27], v[56:59], v[168:171]
    ds_read_b64_tr_b16 v[46:47], v211 offset:4096
    v_mul_f32 v136, v214, v136
    v_mul_f32 v137, v214, v137
    v_mul_f32 v138, v214, v138
    ds_read_b64_tr_b16 v[20:21], v5 offset:0
    v_mul_f32 v139, v214, v139
    v_mfma_f32_16x16x32_bf16 v[172:175], v[24:27], v[60:63], v[172:175]
    v_mul_f32 v140, v215, v140
    v_mul_f32 v141, v215, v141
    ds_read_b64_tr_b16 v[22:23], v5 offset:6144
    v_mul_f32 v142, v215, v142
    v_mul_f32 v143, v215, v143
    s_waitcnt lgkmcnt(12)
    v_mfma_f32_16x16x32_bf16 v[176:179], v[28:31], v[48:51], v[176:179]
    ds_read_b64_tr_b16 v[24:25], v6 offset:0
    v_mul_f32 v144, v212, v144
    v_mul_f32 v145, v212, v145
    v_mul_f32 v146, v212, v146
    v_mul_f32 v147, v212, v147
    v_mfma_f32_16x16x32_bf16 v[180:183], v[28:31], v[52:55], v[180:183]
    v_mul_f32 v148, v213, v148
    v_mul_f32 v149, v213, v149
    v_mul_f32 v150, v213, v150
    v_mul_f32 v151, v213, v151
    v_mfma_f32_16x16x32_bf16 v[184:187], v[28:31], v[56:59], v[184:187]
    ds_read_b64_tr_b16 v[26:27], v6 offset:6144
    v_mul_f32 v152, v214, v152
    v_mul_f32 v153, v214, v153
    v_mul_f32 v154, v214, v154
    v_mul_f32 v155, v214, v155
    v_mfma_f32_16x16x32_bf16 v[188:191], v[28:31], v[60:63], v[188:191]
    v_mul_f32 v156, v215, v156
    v_mul_f32 v157, v215, v157
    v_mul_f32 v158, v215, v158
    v_mul_f32 v159, v215, v159
    s_waitcnt lgkmcnt(4)
    v_mfma_f32_16x16x32_bf16 v[96:99], v[16:19], v[32:35], v[96:99]
    ds_read_b64_tr_b16 v[28:29], v7 offset:0
    v_mul_f32 v160, v212, v160
    v_mul_f32 v161, v212, v161
    v_mul_f32 v162, v212, v162
    v_mul_f32 v163, v212, v163
    v_mfma_f32_16x16x32_bf16 v[100:103], v[16:19], v[36:39], v[100:103]
    v_mul_f32 v164, v213, v164
    v_mul_f32 v165, v213, v165
    v_mul_f32 v166, v213, v166
    v_mul_f32 v167, v213, v167
    v_mfma_f32_16x16x32_bf16 v[104:107], v[16:19], v[40:43], v[104:107]
    ds_read_b64_tr_b16 v[30:31], v7 offset:6144
    v_mul_f32 v168, v214, v168
    v_mul_f32 v169, v214, v169
    v_mul_f32 v170, v214, v170
    v_mul_f32 v171, v214, v171
    v_mfma_f32_16x16x32_bf16 v[108:111], v[16:19], v[44:47], v[108:111]
    v_mul_f32 v172, v215, v172
    v_mul_f32 v173, v215, v173
    v_mul_f32 v174, v215, v174
    v_mul_f32 v175, v215, v175
    s_waitcnt lgkmcnt(4)
    v_mfma_f32_16x16x32_bf16 v[112:115], v[20:23], v[32:35], v[112:115]
    ds_read_b64_tr_b16 v[16:17], v4 offset:128
    v_mul_f32 v176, v212, v176
    v_mul_f32 v177, v212, v177
    v_mul_f32 v178, v212, v178
    v_mul_f32 v179, v212, v179
    v_mfma_f32_16x16x32_bf16 v[116:119], v[20:23], v[36:39], v[116:119]
    ds_read_b64_tr_b16 v[18:19], v4 offset:6272
    v_mul_f32 v180, v213, v180
    v_mul_f32 v181, v213, v181
    v_mul_f32 v182, v213, v182
    v_mul_f32 v183, v213, v183
    v_mfma_f32_16x16x32_bf16 v[120:123], v[20:23], v[40:43], v[120:123]
    ds_read_b64_tr_b16 v[48:49], v208 offset:8192
    v_mul_f32 v184, v214, v184
    v_mul_f32 v185, v214, v185
    v_mul_f32 v186, v214, v186
    v_mul_f32 v187, v214, v187
    v_mfma_f32_16x16x32_bf16 v[124:127], v[20:23], v[44:47], v[124:127]
    ds_read_b64_tr_b16 v[50:51], v208 offset:12288
    v_mul_f32 v188, v215, v188
    v_mul_f32 v189, v215, v189
    v_mul_f32 v190, v215, v190
    v_mul_f32 v191, v215, v191
    s_waitcnt lgkmcnt(6)
    v_mfma_f32_16x16x32_bf16 v[128:131], v[24:27], v[32:35], v[128:131]
    ds_read_b64_tr_b16 v[20:21], v5 offset:128
    v_mfma_f32_16x16x32_bf16 v[132:135], v[24:27], v[36:39], v[132:135]
    ds_read_b64_tr_b16 v[22:23], v5 offset:6272
    v_mfma_f32_16x16x32_bf16 v[136:139], v[24:27], v[40:43], v[136:139]
    ds_read_b64_tr_b16 v[52:53], v209 offset:8192
    v_mfma_f32_16x16x32_bf16 v[140:143], v[24:27], v[44:47], v[140:143]
    ds_read_b64_tr_b16 v[54:55], v209 offset:12288
    s_waitcnt lgkmcnt(8)
    v_mfma_f32_16x16x32_bf16 v[144:147], v[28:31], v[32:35], v[144:147]
    ds_read_b64_tr_b16 v[24:25], v4 offset:12288
    v_mfma_f32_16x16x32_bf16 v[148:151], v[28:31], v[36:39], v[148:151]
    ds_read_b64_tr_b16 v[26:27], v4 offset:18432
    v_mfma_f32_16x16x32_bf16 v[152:155], v[28:31], v[40:43], v[152:155]
    ds_read_b64_tr_b16 v[56:57], v210 offset:8192
    v_mfma_f32_16x16x32_bf16 v[156:159], v[28:31], v[44:47], v[156:159]
    ds_read_b64_tr_b16 v[58:59], v210 offset:12288
    s_waitcnt lgkmcnt(10)
    v_mfma_f32_16x16x32_bf16 v[160:163], v[16:19], v[32:35], v[160:163]
    ds_read_b64_tr_b16 v[28:29], v5 offset:12288
    v_mfma_f32_16x16x32_bf16 v[164:167], v[16:19], v[36:39], v[164:167]
    ds_read_b64_tr_b16 v[30:31], v5 offset:18432
    v_mfma_f32_16x16x32_bf16 v[168:171], v[16:19], v[40:43], v[168:171]
    ds_read_b64_tr_b16 v[60:61], v211 offset:8192
    v_mfma_f32_16x16x32_bf16 v[172:175], v[16:19], v[44:47], v[172:175]
    ds_read_b64_tr_b16 v[62:63], v211 offset:12288
    s_waitcnt lgkmcnt(10)
    v_mfma_f32_16x16x32_bf16 v[176:179], v[20:23], v[32:35], v[176:179]
    ds_read_b64_tr_b16 v[16:17], v6 offset:12288
    v_mfma_f32_16x16x32_bf16 v[180:183], v[20:23], v[36:39], v[180:183]
    v_mfma_f32_16x16x32_bf16 v[184:187], v[20:23], v[40:43], v[184:187]
    ds_read_b64_tr_b16 v[18:19], v6 offset:18432
    v_mfma_f32_16x16x32_bf16 v[188:191], v[20:23], v[44:47], v[188:191]
    s_waitcnt lgkmcnt(2)
    v_mfma_f32_16x16x32_bf16 v[96:99], v[24:27], v[48:51], v[96:99]
    ds_read_b64_tr_b16 v[20:21], v7 offset:12288
    v_mfma_f32_16x16x32_bf16 v[100:103], v[24:27], v[52:55], v[100:103]
    v_mfma_f32_16x16x32_bf16 v[104:107], v[24:27], v[56:59], v[104:107]
    ds_read_b64_tr_b16 v[22:23], v7 offset:18432
    v_mfma_f32_16x16x32_bf16 v[108:111], v[24:27], v[60:63], v[108:111]
    v_mfma_f32_16x16x32_bf16 v[112:115], v[28:31], v[48:51], v[112:115]
    ds_read_b64_tr_b16 v[24:25], v4 offset:12416
    v_mfma_f32_16x16x32_bf16 v[116:119], v[28:31], v[52:55], v[116:119]
    v_mfma_f32_16x16x32_bf16 v[120:123], v[28:31], v[56:59], v[120:123]
    ds_read_b64_tr_b16 v[26:27], v4 offset:18560
    v_mfma_f32_16x16x32_bf16 v[124:127], v[28:31], v[60:63], v[124:127]
    s_waitcnt lgkmcnt(4)
    v_mfma_f32_16x16x32_bf16 v[128:131], v[16:19], v[48:51], v[128:131]
    ds_read_b64_tr_b16 v[28:29], v5 offset:12416
    ds_read_b64_tr_b16 v[30:31], v5 offset:18560
    v_mfma_f32_16x16x32_bf16 v[132:135], v[16:19], v[52:55], v[132:135]
    s_add_u32 s44, s44, 40960
    s_cmp_ge_u32 s44, 163840
    s_cselect_b32 s44, 0, s44
    v_add_u32 v4, s44, v8
    v_mfma_f32_16x16x32_bf16 v[136:139], v[16:19], v[56:59], v[136:139]
    v_add_u32 v5, s44, v9
    v_add_u32 v6, s44, v10
    v_mfma_f32_16x16x32_bf16 v[140:143], v[16:19], v[60:63], v[140:143]
    v_add_u32 v7, s44, v11
    v_add_u32 v12, s44, v13
    s_barrier
    s_waitcnt lgkmcnt(4)
    v_mfma_f32_16x16x32_bf16 v[144:147], v[20:23], v[48:51], v[144:147]
    ds_read_b64_tr_b16 v[64:65], v208 offset:40960
    ds_read_b64_tr_b16 v[66:67], v208 offset:45056
    v_mfma_f32_16x16x32_bf16 v[148:151], v[20:23], v[52:55], v[148:151]
    ds_read_b64_tr_b16 v[68:69], v209 offset:40960
    v_mfma_f32_16x16x32_bf16 v[152:155], v[20:23], v[56:59], v[152:155]
    ds_read_b64_tr_b16 v[70:71], v209 offset:45056
    ds_read_b64_tr_b16 v[16:17], v4 offset:0
    v_mfma_f32_16x16x32_bf16 v[156:159], v[20:23], v[60:63], v[156:159]
    ds_read_b64_tr_b16 v[18:19], v4 offset:6144
    s_waitcnt lgkmcnt(8)
    v_mfma_f32_16x16x32_bf16 v[160:163], v[24:27], v[48:51], v[160:163]
    ds_read_b64_tr_b16 v[72:73], v210 offset:40960
    ds_read_b64_tr_b16 v[74:75], v210 offset:45056
    v_mfma_f32_16x16x32_bf16 v[164:167], v[24:27], v[52:55], v[164:167]
    ds_read_b64_tr_b16 v[76:77], v211 offset:40960
    v_mfma_f32_16x16x32_bf16 v[168:171], v[24:27], v[56:59], v[168:171]
    ds_read_b64_tr_b16 v[78:79], v211 offset:45056
    ds_read_b64_tr_b16 v[20:21], v5 offset:0
    v_mfma_f32_16x16x32_bf16 v[172:175], v[24:27], v[60:63], v[172:175]
    ds_read_b64_tr_b16 v[22:23], v5 offset:6144
    s_waitcnt lgkmcnt(12)
    v_mfma_f32_16x16x32_bf16 v[176:179], v[28:31], v[48:51], v[176:179]
    ds_read_b64_tr_b16 v[24:25], v4 offset:12288
    v_mfma_f32_16x16x32_bf16 v[180:183], v[28:31], v[52:55], v[180:183]
    v_mfma_f32_16x16x32_bf16 v[184:187], v[28:31], v[56:59], v[184:187]
    ds_read_b64_tr_b16 v[26:27], v4 offset:18432
    v_mfma_f32_16x16x32_bf16 v[188:191], v[28:31], v[60:63], v[188:191]
    s_waitcnt lgkmcnt(4)
    v_mfma_f32_16x16x32_bf16 v[96:99], v[16:19], v[64:67], v[96:99]
    ds_read_b64_tr_b16 v[80:81], v208 offset:49152
    ds_read_b64_tr_b16 v[82:83], v208 offset:53248
    ds_read_b64_tr_b16 v[84:85], v209 offset:49152
    ds_read_b64_tr_b16 v[86:87], v209 offset:53248
    v_mfma_f32_16x16x32_bf16 v[100:103], v[16:19], v[68:71], v[100:103]
    ds_read_b64_tr_b16 v[88:89], v210 offset:49152
    ds_read_b64_tr_b16 v[90:91], v210 offset:53248
    ds_read_b64_tr_b16 v[92:93], v211 offset:49152
    v_mfma_f32_16x16x32_bf16 v[104:107], v[16:19], v[72:75], v[104:107]
    ds_read_b64_tr_b16 v[94:95], v211 offset:53248
    v_subrev_u32 v208, 81920, v208
    v_subrev_u32 v209, 81920, v209
    v_subrev_u32 v210, 81920, v210
    v_mfma_f32_16x16x32_bf16 v[108:111], v[16:19], v[76:79], v[108:111]
    v_subrev_u32 v211, 81920, v211
    ds_read_b64_tr_b16 v[28:29], v5 offset:12288
    ds_read_b64_tr_b16 v[30:31], v5 offset:18432
    s_barrier
    s_waitcnt lgkmcnt(12)
    v_mfma_f32_16x16x32_bf16 v[112:115], v[20:23], v[64:67], v[112:115]
    ds_read_b64_tr_b16 v[32:33], v208 offset:0
    ds_read_b64_tr_b16 v[34:35], v208 offset:4096
    v_mfma_f32_16x16x32_bf16 v[116:119], v[20:23], v[68:71], v[116:119]
    ds_read_b64_tr_b16 v[36:37], v209 offset:0
    v_mfma_f32_16x16x32_bf16 v[120:123], v[20:23], v[72:75], v[120:123]
    ds_read_b64_tr_b16 v[38:39], v209 offset:4096
    ds_read_b64_tr_b16 v[16:17], v8 offset:0
    v_mfma_f32_16x16x32_bf16 v[124:127], v[20:23], v[76:79], v[124:127]
    ds_read_b64_tr_b16 v[18:19], v8 offset:6144
    s_waitcnt lgkmcnt(8)
    v_mfma_f32_16x16x32_bf16 v[96:99], v[24:27], v[80:83], v[96:99]
    ds_read_b64_tr_b16 v[40:41], v210 offset:0
    ds_read_b64_tr_b16 v[42:43], v210 offset:4096
    v_mfma_f32_16x16x32_bf16 v[100:103], v[24:27], v[84:87], v[100:103]
    ds_read_b64_tr_b16 v[44:45], v211 offset:0
    v_mfma_f32_16x16x32_bf16 v[104:107], v[24:27], v[88:91], v[104:107]
    ds_read_b64_tr_b16 v[46:47], v211 offset:4096
    ds_read_b64_tr_b16 v[20:21], v9 offset:0
    v_mfma_f32_16x16x32_bf16 v[108:111], v[24:27], v[92:95], v[108:111]
    ds_read_b64_tr_b16 v[22:23], v9 offset:6144
    s_waitcnt lgkmcnt(12)
    v_mfma_f32_16x16x32_bf16 v[112:115], v[28:31], v[80:83], v[112:115]
    ds_read_b64_tr_b16 v[24:25], v6 offset:0
    v_mfma_f32_16x16x32_bf16 v[116:119], v[28:31], v[84:87], v[116:119]
    v_mfma_f32_16x16x32_bf16 v[120:123], v[28:31], v[88:91], v[120:123]
    ds_read_b64_tr_b16 v[26:27], v6 offset:6144
    v_mfma_f32_16x16x32_bf16 v[124:127], v[28:31], v[92:95], v[124:127]
    s_waitcnt lgkmcnt(4)
    v_mfma_f32_16x16x32_bf16 v[96:99], v[16:19], v[32:35], v[96:99]
    ds_read_b64_tr_b16 v[28:29], v7 offset:0
    v_mfma_f32_16x16x32_bf16 v[100:103], v[16:19], v[36:39], v[100:103]
    v_mfma_f32_16x16x32_bf16 v[104:107], v[16:19], v[40:43], v[104:107]
    ds_read_b64_tr_b16 v[30:31], v7 offset:6144
    v_mfma_f32_16x16x32_bf16 v[108:111], v[16:19], v[44:47], v[108:111]
    s_waitcnt lgkmcnt(4)
    v_mfma_f32_16x16x32_bf16 v[112:115], v[20:23], v[32:35], v[112:115]
    ds_read_b64_tr_b16 v[16:17], v6 offset:12288
    v_mfma_f32_16x16x32_bf16 v[116:119], v[20:23], v[36:39], v[116:119]
    v_mfma_f32_16x16x32_bf16 v[120:123], v[20:23], v[40:43], v[120:123]
    ds_read_b64_tr_b16 v[18:19], v6 offset:18432
    v_mfma_f32_16x16x32_bf16 v[124:127], v[20:23], v[44:47], v[124:127]
    s_waitcnt lgkmcnt(4)
    v_mfma_f32_16x16x32_bf16 v[128:131], v[24:27], v[64:67], v[128:131]
    ds_read_b64_tr_b16 v[20:21], v7 offset:12288
    v_mfma_f32_16x16x32_bf16 v[132:135], v[24:27], v[68:71], v[132:135]
    v_mfma_f32_16x16x32_bf16 v[136:139], v[24:27], v[72:75], v[136:139]
    ds_read_b64_tr_b16 v[22:23], v7 offset:18432
    v_mfma_f32_16x16x32_bf16 v[140:143], v[24:27], v[76:79], v[140:143]
    s_waitcnt lgkmcnt(4)
    v_mfma_f32_16x16x32_bf16 v[144:147], v[28:31], v[64:67], v[144:147]
    ds_read_b64_tr_b16 v[24:25], v10 offset:0
    ds_read_b64_tr_b16 v[26:27], v10 offset:6144
    v_mfma_f32_16x16x32_bf16 v[148:151], v[28:31], v[68:71], v[148:151]
    v_cvt_pk_bf16_f32 v192, v96, v97
    v_cvt_pk_bf16_f32 v193, v98, v99
    v_mfma_f32_16x16x32_bf16 v[152:155], v[28:31], v[72:75], v[152:155]
    v_cvt_pk_bf16_f32 v194, v112, v113
    v_cvt_pk_bf16_f32 v195, v114, v115
    v_mfma_f32_16x16x32_bf16 v[156:159], v[28:31], v[76:79], v[156:159]
    buffer_store_dwordx4 v[192:195], v2, s[24:27], s48 offen offset:0 sc1
    s_waitcnt lgkmcnt(4)
    v_mfma_f32_16x16x32_bf16 v[128:131], v[16:19], v[80:83], v[128:131]
    ds_read_b64_tr_b16 v[28:29], v11 offset:0
    ds_read_b64_tr_b16 v[30:31], v11 offset:6144
    v_mfma_f32_16x16x32_bf16 v[132:135], v[16:19], v[84:87], v[132:135]
    v_cvt_pk_bf16_f32 v196, v100, v101
    v_cvt_pk_bf16_f32 v197, v102, v103
    v_mfma_f32_16x16x32_bf16 v[136:139], v[16:19], v[88:91], v[136:139]
    v_cvt_pk_bf16_f32 v198, v116, v117
    v_cvt_pk_bf16_f32 v199, v118, v119
    v_mfma_f32_16x16x32_bf16 v[140:143], v[16:19], v[92:95], v[140:143]
    buffer_store_dwordx4 v[196:199], v2, s[24:27], s49 offen offset:0 sc1
    s_waitcnt lgkmcnt(4)
    v_mfma_f32_16x16x32_bf16 v[144:147], v[20:23], v[80:83], v[144:147]
    ds_read_b64_tr_b16 v[16:17], v4 offset:128
    ds_read_b64_tr_b16 v[18:19], v4 offset:6272
    v_mfma_f32_16x16x32_bf16 v[148:151], v[20:23], v[84:87], v[148:151]
    v_cvt_pk_bf16_f32 v200, v104, v105
    v_cvt_pk_bf16_f32 v201, v106, v107
    v_mfma_f32_16x16x32_bf16 v[152:155], v[20:23], v[88:91], v[152:155]
    v_cvt_pk_bf16_f32 v202, v120, v121
    v_cvt_pk_bf16_f32 v203, v122, v123
    v_mfma_f32_16x16x32_bf16 v[156:159], v[20:23], v[92:95], v[156:159]
    buffer_store_dwordx4 v[200:203], v2, s[24:27], s50 offen offset:0 sc1
    s_waitcnt lgkmcnt(4)
    v_mfma_f32_16x16x32_bf16 v[128:131], v[24:27], v[32:35], v[128:131]
    ds_read_b64_tr_b16 v[20:21], v5 offset:128
    ds_read_b64_tr_b16 v[22:23], v5 offset:6272
    v_mfma_f32_16x16x32_bf16 v[132:135], v[24:27], v[36:39], v[132:135]
    v_cvt_pk_bf16_f32 v204, v108, v109
    v_cvt_pk_bf16_f32 v205, v110, v111
    v_mfma_f32_16x16x32_bf16 v[136:139], v[24:27], v[40:43], v[136:139]
    v_cvt_pk_bf16_f32 v206, v124, v125
    v_cvt_pk_bf16_f32 v207, v126, v127
    v_mfma_f32_16x16x32_bf16 v[140:143], v[24:27], v[44:47], v[140:143]
    buffer_store_dwordx4 v[204:207], v2, s[24:27], s51 offen offset:0 sc1
    s_waitcnt lgkmcnt(4)
    v_mfma_f32_16x16x32_bf16 v[144:147], v[28:31], v[32:35], v[144:147]
    ds_read_b64_tr_b16 v[24:25], v4 offset:12416
    v_mfma_f32_16x16x32_bf16 v[148:151], v[28:31], v[36:39], v[148:151]
    v_mfma_f32_16x16x32_bf16 v[152:155], v[28:31], v[40:43], v[152:155]
    ds_read_b64_tr_b16 v[26:27], v4 offset:18560
    v_mfma_f32_16x16x32_bf16 v[156:159], v[28:31], v[44:47], v[156:159]
    s_waitcnt lgkmcnt(4)
    v_mfma_f32_16x16x32_bf16 v[160:163], v[16:19], v[64:67], v[160:163]
    ds_read_b64_tr_b16 v[28:29], v5 offset:12416
    v_mfma_f32_16x16x32_bf16 v[164:167], v[16:19], v[68:71], v[164:167]
    v_mfma_f32_16x16x32_bf16 v[168:171], v[16:19], v[72:75], v[168:171]
    ds_read_b64_tr_b16 v[30:31], v5 offset:18560
    v_mfma_f32_16x16x32_bf16 v[172:175], v[16:19], v[76:79], v[172:175]
    s_waitcnt lgkmcnt(4)
    v_mfma_f32_16x16x32_bf16 v[176:179], v[20:23], v[64:67], v[176:179]
    ds_read_b64_tr_b16 v[16:17], v8 offset:128
    ds_read_b64_tr_b16 v[18:19], v8 offset:6272
    v_mfma_f32_16x16x32_bf16 v[180:183], v[20:23], v[68:71], v[180:183]
    v_cvt_pk_bf16_f32 v192, v128, v129
    v_cvt_pk_bf16_f32 v193, v130, v131
    v_mfma_f32_16x16x32_bf16 v[184:187], v[20:23], v[72:75], v[184:187]
    v_cvt_pk_bf16_f32 v194, v144, v145
    v_cvt_pk_bf16_f32 v195, v146, v147
    v_mfma_f32_16x16x32_bf16 v[188:191], v[20:23], v[76:79], v[188:191]
    buffer_store_dwordx4 v[192:195], v2, s[24:27], s48 offen offset:1024 sc1
    s_waitcnt lgkmcnt(4)
    v_mfma_f32_16x16x32_bf16 v[160:163], v[24:27], v[80:83], v[160:163]
    ds_read_b64_tr_b16 v[20:21], v9 offset:128
    ds_read_b64_tr_b16 v[22:23], v9 offset:6272
    v_mfma_f32_16x16x32_bf16 v[164:167], v[24:27], v[84:87], v[164:167]
    v_cvt_pk_bf16_f32 v196, v132, v133
    v_cvt_pk_bf16_f32 v197, v134, v135
    v_mfma_f32_16x16x32_bf16 v[168:171], v[24:27], v[88:91], v[168:171]
    v_cvt_pk_bf16_f32 v198, v148, v149
    v_cvt_pk_bf16_f32 v199, v150, v151
    v_mfma_f32_16x16x32_bf16 v[172:175], v[24:27], v[92:95], v[172:175]
    buffer_store_dwordx4 v[196:199], v2, s[24:27], s49 offen offset:1024 sc1
    s_waitcnt lgkmcnt(4)
    v_mfma_f32_16x16x32_bf16 v[176:179], v[28:31], v[80:83], v[176:179]
    v_cvt_pk_bf16_f32 v200, v136, v137
    v_cvt_pk_bf16_f32 v201, v138, v139
    v_mfma_f32_16x16x32_bf16 v[180:183], v[28:31], v[84:87], v[180:183]
    v_cvt_pk_bf16_f32 v202, v152, v153
    v_mfma_f32_16x16x32_bf16 v[184:187], v[28:31], v[88:91], v[184:187]
    v_cvt_pk_bf16_f32 v203, v154, v155
    v_mfma_f32_16x16x32_bf16 v[188:191], v[28:31], v[92:95], v[188:191]
    buffer_store_dwordx4 v[200:203], v2, s[24:27], s50 offen offset:1024 sc1
    s_waitcnt lgkmcnt(2)
    v_mfma_f32_16x16x32_bf16 v[160:163], v[16:19], v[32:35], v[160:163]
    v_cvt_pk_bf16_f32 v204, v140, v141
    v_cvt_pk_bf16_f32 v205, v142, v143
    v_mfma_f32_16x16x32_bf16 v[164:167], v[16:19], v[36:39], v[164:167]
    v_cvt_pk_bf16_f32 v206, v156, v157
    v_mfma_f32_16x16x32_bf16 v[168:171], v[16:19], v[40:43], v[168:171]
    v_cvt_pk_bf16_f32 v207, v158, v159
    v_mfma_f32_16x16x32_bf16 v[172:175], v[16:19], v[44:47], v[172:175]
    buffer_store_dwordx4 v[204:207], v2, s[24:27], s51 offen offset:1024 sc1
    s_waitcnt lgkmcnt(0)
    v_mfma_f32_16x16x32_bf16 v[176:179], v[20:23], v[32:35], v[176:179]
    v_mfma_f32_16x16x32_bf16 v[180:183], v[20:23], v[36:39], v[180:183]
    v_mfma_f32_16x16x32_bf16 v[184:187], v[20:23], v[40:43], v[184:187]
    v_mfma_f32_16x16x32_bf16 v[188:191], v[20:23], v[44:47], v[188:191]
    s_nop 7
    v_cvt_pk_bf16_f32 v192, v160, v161
    v_cvt_pk_bf16_f32 v193, v162, v163
    v_cvt_pk_bf16_f32 v194, v176, v177
    v_cvt_pk_bf16_f32 v195, v178, v179
    buffer_store_dwordx4 v[192:195], v2, s[24:27], s48 offen offset:2048 sc1
    v_cvt_pk_bf16_f32 v196, v164, v165
    v_cvt_pk_bf16_f32 v197, v166, v167
    v_cvt_pk_bf16_f32 v198, v180, v181
    v_cvt_pk_bf16_f32 v199, v182, v183
    buffer_store_dwordx4 v[196:199], v2, s[24:27], s49 offen offset:2048 sc1
    v_cvt_pk_bf16_f32 v200, v168, v169
    v_cvt_pk_bf16_f32 v201, v170, v171
    v_cvt_pk_bf16_f32 v202, v184, v185
    v_cvt_pk_bf16_f32 v203, v186, v187
    buffer_store_dwordx4 v[200:203], v2, s[24:27], s50 offen offset:2048 sc1
    v_cvt_pk_bf16_f32 v204, v172, v173
    v_cvt_pk_bf16_f32 v205, v174, v175
    v_cvt_pk_bf16_f32 v206, v188, v189
    v_cvt_pk_bf16_f32 v207, v190, v191
    buffer_store_dwordx4 v[204:207], v2, s[24:27], s51 offen offset:2048 sc1
    s_waitcnt vmcnt(0)
    s_barrier
    s_branch K2_RED
K2_LOAD:
    s_sub_u32 s54, s36, 4
    s_mul_i32 s52, s39, 384
    v_add_u32 v16, 0, v1
    v_mul_u32_u24 v17, 2731, v16
    v_lshrrev_b32 v17, 16, v17
    v_mul_u32_u24 v18, 24, v17
    v_sub_u32 v18, v16, v18
    v_and_b32 v19, 6, v17
    v_xor_b32 v18, v18, v19
    v_mul_u32_u24 v17, 1152, v17
    v_lshl_add_u32 v17, v18, 4, v17
    v_add_u32 v4, s52, v17
    v_add_u32 v16, 64, v1
    v_mul_u32_u24 v17, 2731, v16
    v_lshrrev_b32 v17, 16, v17
    v_mul_u32_u24 v18, 24, v17
    v_sub_u32 v18, v16, v18
    v_and_b32 v19, 6, v17
    v_xor_b32 v18, v18, v19
    v_mul_u32_u24 v17, 1152, v17
    v_lshl_add_u32 v17, v18, 4, v17
    v_add_u32 v5, s52, v17
    v_add_u32 v16, 128, v1
    v_mul_u32_u24 v17, 2731, v16
    v_lshrrev_b32 v17, 16, v17
    v_mul_u32_u24 v18, 24, v17
    v_sub_u32 v18, v16, v18
    v_and_b32 v19, 6, v17
    v_xor_b32 v18, v18, v19
    v_mul_u32_u24 v17, 1152, v17
    v_lshl_add_u32 v17, v18, 4, v17
    v_add_u32 v6, s52, v17
    s_and_b32 s53, s54, 1
    s_mul_i32 s22, s37, 72
    s_add_u32 s22, s22, s53
    s_mul_i32 s22, s22, 18432
    s_and_b32 s29, s54, 2
    s_mov_b32 s21, 0
    s_mul_i32 s42, s54, 6144
    s_lshl_b32 s46, s54, 12
    s_add_u32 s46, s46, 24576
    s_mov_b32 s16, s92
    s_and_b32 s17, s93, 0xffff
    s_mov_b32 s18, 0x510000
    s_mov_b32 s19, 0x20000
    s_lshl_b32 s52, s38, 1
    s_add_u32 s52, s52, s53
    s_mul_i32 s23, s52, 593920
    s_mul_i32 s52, s37, 36864
    s_add_u32 s23, s23, s52
    s_lshr_b32 s20, s28, 1
    s_mul_i32 s20, s20, 9
    s_bitcmp1_b32 s28, 0
    s_cselect_b32 s52, 5, 0
    s_add_u32 s20, s20, s52
    s_add_u32 s20, s20, s29
    s_mul_i32 s40, s20, 36864
    s_add_u32 s40, s40, s22
    s_add_u32 s41, s40, 9216
    s_lshl_b32 s45, s20, 10
    s_add_u32 s45, s45, s23
    s_add_u32 m0, s42, 0
    s_nop 0
    buffer_load_dwordx4 v4, s[16:19], s40 offen  lds
    s_add_u32 m0, s42, 1024
    s_nop 0
    buffer_load_dwordx4 v5, s[16:19], s40 offen  lds
    s_add_u32 m0, s42, 2048
    s_nop 0
    buffer_load_dwordx4 v6, s[16:19], s40 offen  lds
    s_add_u32 m0, s42, 3072
    s_nop 0
    buffer_load_dwordx4 v4, s[16:19], s41 offen  lds
    s_add_u32 m0, s42, 4096
    s_nop 0
    buffer_load_dwordx4 v5, s[16:19], s41 offen  lds
    s_add_u32 m0, s42, 5120
    s_nop 0
    buffer_load_dwordx4 v6, s[16:19], s41 offen  lds
    s_add_u32 s42, s42, 40960
    s_add_u32 s40, s40, 36864
    s_add_u32 s41, s41, 36864
    s_add_u32 m0, s42, 0
    s_nop 0
    buffer_load_dwordx4 v4, s[16:19], s40 offen  lds
    s_add_u32 m0, s42, 1024
    s_nop 0
    buffer_load_dwordx4 v5, s[16:19], s40 offen  lds
    s_add_u32 m0, s42, 2048
    s_nop 0
    buffer_load_dwordx4 v6, s[16:19], s40 offen  lds
    s_add_u32 m0, s42, 3072
    s_nop 0
    buffer_load_dwordx4 v4, s[16:19], s41 offen  lds
    s_add_u32 m0, s42, 4096
    s_nop 0
    buffer_load_dwordx4 v5, s[16:19], s41 offen  lds
    s_add_u32 m0, s42, 5120
    s_nop 0
    buffer_load_dwordx4 v6, s[16:19], s41 offen  lds
    s_add_u32 s42, s42, 40960
    s_add_u32 s46, s46, 81920
    v_add_u32 v8, 0, v2
    v_add_u32 v9, 148480, v2
    v_add_u32 v10, 296960, v2
    v_add_u32 v11, 445440, v2
    v_bfe_u32 v15, v1, 1, 1
    v_lshlrev_b32 v15, 9, v15
    v_lshrrev_b32 v16, 2, v1
    v_lshl_add_u32 v15, v16, 3, v15
    v_and_b32 v16, 1, v1
    v_lshl_add_u32 v15, v16, 2, v15
    s_lshr_b32 s52, s38, 1
    s_lshl_b32 s52, s52, 2
    s_add_u32 s52, s52, s37
    s_lshl_b32 s52, s52, 1
    s_and_b32 s53, s38, 1
    s_add_u32 s52, s52, s53
    s_lshl_b32 s52, s52, 7
    s_add_u32 s57, s52, 36962560
    v_and_b32 v20, 31, v1
    v_lshlrev_b32 v20, 2, v20
    v_min_u32 v26, 92, v20
    s_mul_i32 s61, s37, 9
    s_add_u32 s61, s61, s54
    s_mul_i32 s61, s61, 18432
    s_add_u32 s61, s61, 36274432
    s_mul_i32 s60, s37, 144
    s_lshl_b32 s52, s54, 4
    s_add_u32 s60, s60, s52
    s_mul_i32 s60, s60, 4224
    s_lshl_b32 s52, s38, 7
    s_add_u32 s60, s60, s52
    s_add_u32 s60, s60, 23879936
    v_lshrrev_b32 v16, 4, v1
    v_mul_u32_u24 v17, 4224, v16
    v_and_b32 v18, 1, v1
    v_lshl_add_u32 v17, v18, 4, v17
    v_bfe_u32 v18, v1, 1, 3
    v_xor_b32 v16, v16, v18
    v_and_b32 v18, 1, v16
    v_lshl_add_u32 v18, v18, 11, v17
    v_lshrrev_b32 v19, 1, v16
    v_lshl_add_u32 v12, v19, 5, v18
    v_xor_b32 v16, 4, v16
    v_add_u32 v17, 16896, v17
    v_and_b32 v18, 1, v16
    v_lshl_add_u32 v18, v18, 11, v17
    v_lshrrev_b32 v19, 1, v16
    v_lshl_add_u32 v13, v19, 5, v18
    v_lshlrev_b32 v14, 2, v1
    s_mov_b32 s55, 36987136
    s_waitcnt vmcnt(6) lgkmcnt(0)
    s_barrier
    s_cmp_ge_u32 s21, s28
    s_addc_u32 s53, s21, 0
    s_add_u32 s21, s21, 1
    s_lshr_b32 s20, s53, 1
    s_mul_i32 s20, s20, 9
    s_bitcmp1_b32 s53, 0
    s_cselect_b32 s52, 5, 0
    s_add_u32 s20, s20, s52
    s_add_u32 s20, s20, s29
    s_mul_i32 s40, s20, 36864
    s_add_u32 s40, s40, s22
    s_add_u32 s41, s40, 9216
    s_lshl_b32 s45, s20, 10
    s_add_u32 s45, s45, s23
    s_add_u32 m0, s42, 0
    s_nop 0
    buffer_load_dwordx4 v4, s[16:19], s40 offen  lds
    s_add_u32 m0, s42, 1024
    s_nop 0
    buffer_load_dwordx4 v5, s[16:19], s40 offen  lds
    s_add_u32 m0, s42, 2048
    s_nop 0
    buffer_load_dwordx4 v6, s[16:19], s40 offen  lds
    s_add_u32 m0, s42, 3072
    s_nop 0
    buffer_load_dwordx4 v4, s[16:19], s41 offen  lds
    s_add_u32 m0, s42, 4096
    s_nop 0
    buffer_load_dwordx4 v5, s[16:19], s41 offen  lds
    s_add_u32 m0, s42, 5120
    s_nop 0
    buffer_load_dwordx4 v6, s[16:19], s41 offen  lds
    s_mov_b32 s58, s45
    s_add_u32 s42, s42, 40960
    s_cmp_ge_u32 s21, s28
    s_addc_u32 s53, s21, 0
    s_add_u32 s21, s21, 1
    s_lshr_b32 s20, s53, 1
    s_mul_i32 s20, s20, 9
    s_bitcmp1_b32 s53, 0
    s_cselect_b32 s52, 5, 0
    s_add_u32 s20, s20, s52
    s_add_u32 s20, s20, s29
    s_mul_i32 s40, s20, 36864
    s_add_u32 s40, s40, s22
    s_add_u32 s41, s40, 9216
    s_lshl_b32 s45, s20, 10
    s_add_u32 s45, s45, s23
    s_add_u32 m0, s42, 0
    s_nop 0
    buffer_load_dwordx4 v4, s[16:19], s40 offen  lds
    s_add_u32 m0, s42, 1024
    s_nop 0
    buffer_load_dwordx4 v5, s[16:19], s40 offen  lds
    s_add_u32 m0, s42, 2048
    s_nop 0
    buffer_load_dwordx4 v6, s[16:19], s40 offen  lds
    s_add_u32 m0, s42, 3072
    s_nop 0
    buffer_load_dwordx4 v4, s[16:19], s41 offen  lds
    s_add_u32 m0, s42, 4096
    s_nop 0
    buffer_load_dwordx4 v5, s[16:19], s41 offen  lds
    s_add_u32 m0, s42, 5120
    s_nop 0
    buffer_load_dwordx4 v6, s[16:19], s41 offen  lds
    s_sub_u32 s42, s42, 122880
    s_waitcnt vmcnt(12)
    s_barrier
    v_mov_b32 v21, 24576
    s_cmp_lg_u32 s36, 4
    s_cbranch_scc1 K2_HL
    s_mov_b32 s47, 65536
K2_HSP:
    buffer_load_dword v16, v26, s[24:27], s57 offen sc1
    s_waitcnt vmcnt(0)
K2_HSP_C:
    v_xor_b32 v16, s62, v16
    v_cmp_ne_u32 vcc, 0, v16
    s_cbranch_vccz K2_HSP_OK
    s_sleep 1
    s_sub_u32 s47, s47, 1
    s_cmp_lg_u32 s47, 0
    s_cbranch_scc1 K2_HSP
K2_HSP_OK:
    v_mov_b32 v16, s62
    ds_write_b32 v21, v16
    s_branch K2_HL_OK
K2_HL:
    s_mov_b32 s47, 1048576
K2_HL1:
    ds_read_b32 v16, v21
    s_waitcnt lgkmcnt(0)
    v_cmp_ne_u32 vcc, s62, v16
    s_cbranch_vccz K2_HL_OK
    s_sleep 1
    s_sub_u32 s47, s47, 1
    s_cmp_lg_u32 s47, 0
    s_cbranch_scc1 K2_HL1
K2_HL_OK:
    s_add_u32 m0, s46, 0
    s_nop 0
    buffer_load_dwordx4 v8, s[24:27], s58 offen sc1 lds
    s_add_u32 m0, s46, 1024
    s_nop 0
    buffer_load_dwordx4 v9, s[24:27], s58 offen sc1 lds
    s_add_u32 m0, s46, 2048
    s_nop 0
    buffer_load_dwordx4 v10, s[24:27], s58 offen sc1 lds
    s_add_u32 m0, s46, 3072
    s_nop 0
    buffer_load_dwordx4 v11, s[24:27], s58 offen sc1 lds
    s_add_u32 s46, s46, 40960
    s_add_u32 m0, s46, 0
    s_nop 0
    buffer_load_dwordx4 v8, s[24:27], s45 offen sc1 lds
    s_add_u32 m0, s46, 1024
    s_nop 0
    buffer_load_dwordx4 v9, s[24:27], s45 offen sc1 lds
    s_add_u32 m0, s46, 2048
    s_nop 0
    buffer_load_dwordx4 v10, s[24:27], s45 offen sc1 lds
    s_add_u32 m0, s46, 3072
    s_nop 0
    buffer_load_dwordx4 v11, s[24:27], s45 offen sc1 lds
    s_sub_u32 s46, s46, 122880
    buffer_store_dwordx4 v[176:179], v2, s[24:27], s4 offen offset:1024 sc1
    buffer_store_dwordx4 v[180:183], v2, s[24:27], s5 offen offset:1024 sc1
    buffer_store_dwordx4 v[184:187], v2, s[24:27], s6 offen offset:1024 sc1
    buffer_store_dwordx4 v[188:191], v2, s[24:27], s7 offen offset:1024 sc1
    s_waitcnt vmcnt(8) lgkmcnt(0)
    s_barrier
    s_cmp_ge_u32 s21, s28
    s_addc_u32 s53, s21, 0
    s_add_u32 s21, s21, 1
    s_lshr_b32 s20, s53, 1
    s_mul_i32 s20, s20, 9
    s_bitcmp1_b32 s53, 0
    s_cselect_b32 s52, 5, 0
    s_add_u32 s20, s20, s52
    s_add_u32 s20, s20, s29
    s_mul_i32 s40, s20, 36864
    s_add_u32 s40, s40, s22
    s_add_u32 s41, s40, 9216
    s_lshl_b32 s45, s20, 10
    s_add_u32 s45, s45, s23
    s_add_u32 m0, s42, 0
    s_nop 0
    buffer_load_dwordx4 v4, s[16:19], s40 offen  lds
    s_add_u32 m0, s42, 1024
    s_nop 0
    buffer_load_dwordx4 v5, s[16:19], s40 offen  lds
    s_add_u32 m0, s42, 2048
    s_nop 0
    buffer_load_dwordx4 v6, s[16:19], s40 offen  lds
    s_add_u32 m0, s42, 3072
    s_nop 0
    buffer_load_dwordx4 v4, s[16:19], s41 offen  lds
    s_add_u32 m0, s42, 4096
    s_nop 0
    buffer_load_dwordx4 v5, s[16:19], s41 offen  lds
    s_add_u32 m0, s42, 5120
    s_nop 0
    buffer_load_dwordx4 v6, s[16:19], s41 offen  lds
    s_add_u32 m0, s46, 0
    s_nop 0
    buffer_load_dwordx4 v8, s[24:27], s45 offen sc1 lds
    s_add_u32 m0, s46, 1024
    s_nop 0
    buffer_load_dwordx4 v9, s[24:27], s45 offen sc1 lds
    s_add_u32 m0, s46, 2048
    s_nop 0
    buffer_load_dwordx4 v10, s[24:27], s45 offen sc1 lds
    s_add_u32 m0, s46, 3072
    s_nop 0
    buffer_load_dwordx4 v11, s[24:27], s45 offen sc1 lds
    s_add_u32 s42, s42, 40960
    s_add_u32 s46, s46, 40960
    s_cmp_ge_u32 s42, 163840
    s_cselect_b32 s52, 163840, 0
    s_sub_u32 s42, s42, s52
    s_sub_u32 s46, s46, s52
    s_waitcnt vmcnt(14)
    s_barrier
    s_cmp_ge_u32 s21, s28
    s_addc_u32 s53, s21, 0
    s_add_u32 s21, s21, 1
    s_lshr_b32 s20, s53, 1
    s_mul_i32 s20, s20, 9
    s_bitcmp1_b32 s53, 0
    s_cselect_b32 s52, 5, 0
    s_add_u32 s20, s20, s52
    s_add_u32 s20, s20, s29
    s_mul_i32 s40, s20, 36864
    s_add_u32 s40, s40, s22
    s_add_u32 s41, s40, 9216
    s_lshl_b32 s45, s20, 10
    s_add_u32 s45, s45, s23
    s_add_u32 m0, s42, 0
    s_nop 0
    buffer_load_dwordx4 v4, s[16:19], s40 offen  lds
    s_add_u32 m0, s42, 1024
    s_nop 0
    buffer_load_dwordx4 v5, s[16:19], s40 offen  lds
    s_add_u32 m0, s42, 2048
    s_nop 0
    buffer_load_dwordx4 v6, s[16:19], s40 offen  lds
    s_add_u32 m0, s42, 3072
    s_nop 0
    buffer_load_dwordx4 v4, s[16:19], s41 offen  lds
    s_add_u32 m0, s42, 4096
    s_nop 0
    buffer_load_dwordx4 v5, s[16:19], s41 offen  lds
    s_add_u32 m0, s42, 5120
    s_nop 0
    buffer_load_dwordx4 v6, s[16:19], s41 offen  lds
    s_add_u32 m0, s46, 0
    s_nop 0
    buffer_load_dwordx4 v8, s[24:27], s45 offen sc1 lds
    s_add_u32 m0, s46, 1024
    s_nop 0
    buffer_load_dwordx4 v9, s[24:27], s45 offen sc1 lds
    s_add_u32 m0, s46, 2048
    s_nop 0
    buffer_load_dwordx4 v10, s[24:27], s45 offen sc1 lds
    s_add_u32 m0, s46, 3072
    s_nop 0
    buffer_load_dwordx4 v11, s[24:27], s45 offen sc1 lds
    s_add_u32 s42, s42, 40960
    s_add_u32 s46, s46, 40960
    s_cmp_ge_u32 s42, 163840
    s_cselect_b32 s52, 163840, 0
    s_sub_u32 s42, s42, s52
    s_sub_u32 s46, s46, s52
    s_waitcnt vmcnt(10)
    v_mov_b32 v22, s62
    v_mov_b32 v23, 0
    s_mov_b64 exec, 1
    buffer_store_dword v22, v23, s[24:27], s63 offen sc1
    s_mov_b64 exec, -1
    s_add_u32 s63, s63, 8192
    v_mov_b32 v24, s62
    v_mov_b32 v25, 0
    s_mov_b64 exec, 1
    buffer_store_dword v24, v25, s[24:27], s63 offen sc1
    s_mov_b64 exec, -1
    s_barrier
    buffer_load_dword v16, v20, s[24:27], s57 offen sc1
    s_cmp_ge_u32 s21, s28
    s_addc_u32 s53, s21, 0
    s_add_u32 s21, s21, 1
    s_lshr_b32 s20, s53, 1
    s_mul_i32 s20, s20, 9
    s_bitcmp1_b32 s53, 0
    s_cselect_b32 s52, 5, 0
    s_add_u32 s20, s20, s52
    s_add_u32 s20, s20, s29
    s_mul_i32 s40, s20, 36864
    s_add_u32 s40, s40, s22
    s_add_u32 s41, s40, 9216
    s_lshl_b32 s45, s20, 10
    s_add_u32 s45, s45, s23
    s_add_u32 m0, s42, 0
    s_nop 0
    buffer_load_dwordx4 v4, s[16:19], s40 offen  lds
    s_add_u32 m0, s42, 1024
    s_nop 0
    buffer_load_dwordx4 v5, s[16:19], s40 offen  lds
    s_add_u32 m0, s42, 2048
    s_nop 0
    buffer_load_dwordx4 v6, s[16:19], s40 offen  lds
    s_add_u32 m0, s42, 3072
    s_nop 0
    buffer_load_dwordx4 v4, s[16:19], s41 offen  lds
    s_add_u32 m0, s42, 4096
    s_nop 0
    buffer_load_dwordx4 v5, s[16:19], s41 offen  lds
    s_add_u32 m0, s42, 5120
    s_nop 0
    buffer_load_dwordx4 v6, s[16:19], s41 offen  lds
    s_add_u32 m0, s46, 0
    s_nop 0
    buffer_load_dwordx4 v8, s[24:27], s45 offen sc1 lds
    s_add_u32 m0, s46, 1024
    s_nop 0
    buffer_load_dwordx4 v9, s[24:27], s45 offen sc1 lds
    s_add_u32 m0, s46, 2048
    s_nop 0
    buffer_load_dwordx4 v10, s[24:27], s45 offen sc1 lds
    s_add_u32 m0, s46, 3072
    s_nop 0
    buffer_load_dwordx4 v11, s[24:27], s45 offen sc1 lds
    s_add_u32 s42, s42, 40960
    s_add_u32 s46, s46, 40960
    s_cmp_ge_u32 s42, 163840
    s_cselect_b32 s52, 163840, 0
    s_sub_u32 s42, s42, s52
    s_sub_u32 s46, s46, s52
    s_waitcnt vmcnt(10)
    s_cmp_lg_u32 s36, 4
    s_cbranch_scc1 K2_H0_OK
    s_mov_b32 s47, 65536
    s_branch K2_H0_C
    s_mov_b32 s47, 65536
K2_H0:
    buffer_load_dword v16, v20, s[24:27], s57 offen sc1
    s_waitcnt vmcnt(0)
K2_H0_C:
    v_xor_b32 v16, s62, v16
    v_cmp_ne_u32 vcc, 0, v16
    s_cbranch_vccz K2_H0_OK
    s_sleep 8
    s_sub_u32 s47, s47, 1
    s_cmp_lg_u32 s47, 0
    s_cbranch_scc1 K2_H0
K2_H0_OK:
    s_barrier
    s_cmp_ge_u32 s21, s28
    s_addc_u32 s53, s21, 0
    s_add_u32 s21, s21, 1
    s_lshr_b32 s20, s53, 1
    s_mul_i32 s20, s20, 9
    s_bitcmp1_b32 s53, 0
    s_cselect_b32 s52, 5, 0
    s_add_u32 s20, s20, s52
    s_add_u32 s20, s20, s29
    s_mul_i32 s40, s20, 36864
    s_add_u32 s40, s40, s22
    s_add_u32 s41, s40, 9216
    s_lshl_b32 s45, s20, 10
    s_add_u32 s45, s45, s23
    s_add_u32 m0, s42, 0
    s_nop 0
    buffer_load_dwordx4 v4, s[16:19], s40 offen  lds
    s_add_u32 m0, s42, 1024
    s_nop 0
    buffer_load_dwordx4 v5, s[16:19], s40 offen  lds
    s_add_u32 m0, s42, 2048
    s_nop 0
    buffer_load_dwordx4 v6, s[16:19], s40 offen  lds
    s_add_u32 m0, s42, 3072
    s_nop 0
    buffer_load_dwordx4 v4, s[16:19], s41 offen  lds
    s_add_u32 m0, s42, 4096
    s_nop 0
    buffer_load_dwordx4 v5, s[16:19], s41 offen  lds
    s_add_u32 m0, s42, 5120
    s_nop 0
    buffer_load_dwordx4 v6, s[16:19], s41 offen  lds
    s_add_u32 m0, s46, 0
    s_nop 0
    buffer_load_dwordx4 v8, s[24:27], s45 offen sc1 lds
    s_add_u32 m0, s46, 1024
    s_nop 0
    buffer_load_dwordx4 v9, s[24:27], s45 offen sc1 lds
    s_add_u32 m0, s46, 2048
    s_nop 0
    buffer_load_dwordx4 v10, s[24:27], s45 offen sc1 lds
    s_add_u32 m0, s46, 3072
    s_nop 0
    buffer_load_dwordx4 v11, s[24:27], s45 offen sc1 lds
    s_add_u32 s42, s42, 40960
    s_add_u32 s46, s46, 40960
    s_cmp_ge_u32 s42, 163840
    s_cselect_b32 s52, 163840, 0
    s_sub_u32 s42, s42, s52
    s_sub_u32 s46, s46, s52
    s_add_u32 s57, s57, 8192
    s_waitcnt vmcnt(10)
    s_barrier
    buffer_load_dword v16, v26, s[24:27], s57 offen sc1
    s_cmp_ge_u32 s21, s28
    s_addc_u32 s53, s21, 0
    s_add_u32 s21, s21, 1
    s_lshr_b32 s20, s53, 1
    s_mul_i32 s20, s20, 9
    s_bitcmp1_b32 s53, 0
    s_cselect_b32 s52, 5, 0
    s_add_u32 s20, s20, s52
    s_add_u32 s20, s20, s29
    s_mul_i32 s40, s20, 36864
    s_add_u32 s40, s40, s22
    s_add_u32 s41, s40, 9216
    s_lshl_b32 s45, s20, 10
    s_add_u32 s45, s45, s23
    s_add_u32 m0, s42, 0
    s_nop 0
    buffer_load_dwordx4 v4, s[16:19], s40 offen  lds
    s_add_u32 m0, s42, 1024
    s_nop 0
    buffer_load_dwordx4 v5, s[16:19], s40 offen  lds
    s_add_u32 m0, s42, 2048
    s_nop 0
    buffer_load_dwordx4 v6, s[16:19], s40 offen  lds
    s_add_u32 m0, s42, 3072
    s_nop 0
    buffer_load_dwordx4 v4, s[16:19], s41 offen  lds
    s_add_u32 m0, s42, 4096
    s_nop 0
    buffer_load_dwordx4 v5, s[16:19], s41 offen  lds
    s_add_u32 m0, s42, 5120
    s_nop 0
    buffer_load_dwordx4 v6, s[16:19], s41 offen  lds
    s_add_u32 m0, s46, 0
    s_nop 0
    buffer_load_dwordx4 v8, s[24:27], s45 offen sc1 lds
    s_add_u32 m0, s46, 1024
    s_nop 0
    buffer_load_dwordx4 v9, s[24:27], s45 offen sc1 lds
    s_add_u32 m0, s46, 2048
    s_nop 0
    buffer_load_dwordx4 v10, s[24:27], s45 offen sc1 lds
    s_add_u32 m0, s46, 3072
    s_nop 0
    buffer_load_dwordx4 v11, s[24:27], s45 offen sc1 lds
    s_add_u32 s42, s42, 40960
    s_add_u32 s46, s46, 40960
    s_cmp_ge_u32 s42, 163840
    s_cselect_b32 s52, 163840, 0
    s_sub_u32 s42, s42, s52
    s_sub_u32 s46, s46, s52
    s_waitcnt vmcnt(10)
    s_cmp_lg_u32 s36, 4
    s_cbranch_scc1 K2_H1_OK
    s_mov_b32 s47, 65536
    s_branch K2_H1_C
    s_mov_b32 s47, 65536
K2_H1:
    buffer_load_dword v16, v26, s[24:27], s57 offen sc1
    s_waitcnt vmcnt(0)
K2_H1_C:
    v_xor_b32 v16, s62, v16
    v_cmp_ne_u32 vcc, 0, v16
    s_cbranch_vccz K2_H1_OK
    s_sleep 8
    s_sub_u32 s47, s47, 1
    s_cmp_lg_u32 s47, 0
    s_cbranch_scc1 K2_H1
K2_H1_OK:
    s_mov_b32 s21, 0
    s_add_u32 s29, s29, 1
    s_barrier
    s_cmp_ge_u32 s21, s28
    s_addc_u32 s53, s21, 0
    s_add_u32 s21, s21, 1
    s_lshr_b32 s20, s53, 1
    s_mul_i32 s20, s20, 9
    s_bitcmp1_b32 s53, 0
    s_cselect_b32 s52, 5, 0
    s_add_u32 s20, s20, s52
    s_add_u32 s20, s20, s29
    s_mul_i32 s40, s20, 36864
    s_add_u32 s40, s40, s22
    s_add_u32 s41, s40, 9216
    s_lshl_b32 s45, s20, 10
    s_add_u32 s45, s45, s23
    s_add_u32 m0, s42, 0
    s_nop 0
    buffer_load_dwordx4 v4, s[16:19], s40 offen  lds
    s_add_u32 m0, s42, 1024
    s_nop 0
    buffer_load_dwordx4 v5, s[16:19], s40 offen  lds
    s_add_u32 m0, s42, 2048
    s_nop 0
    buffer_load_dwordx4 v6, s[16:19], s40 offen  lds
    s_add_u32 m0, s42, 3072
    s_nop 0
    buffer_load_dwordx4 v4, s[16:19], s41 offen  lds
    s_add_u32 m0, s42, 4096
    s_nop 0
    buffer_load_dwordx4 v5, s[16:19], s41 offen  lds
    s_add_u32 m0, s42, 5120
    s_nop 0
    buffer_load_dwordx4 v6, s[16:19], s41 offen  lds
    s_add_u32 m0, s46, 0
    s_nop 0
    buffer_load_dwordx4 v8, s[24:27], s45 offen sc1 lds
    s_add_u32 m0, s46, 1024
    s_nop 0
    buffer_load_dwordx4 v9, s[24:27], s45 offen sc1 lds
    s_add_u32 m0, s46, 2048
    s_nop 0
    buffer_load_dwordx4 v10, s[24:27], s45 offen sc1 lds
    s_add_u32 m0, s46, 3072
    s_nop 0
    buffer_load_dwordx4 v11, s[24:27], s45 offen sc1 lds
    s_add_u32 s42, s42, 40960
    s_add_u32 s46, s46, 40960
    s_cmp_ge_u32 s42, 163840
    s_cselect_b32 s52, 163840, 0
    s_sub_u32 s42, s42, s52
    s_sub_u32 s46, s46, s52
    s_mov_b32 s43, 3
K2_LL1:
    s_waitcnt vmcnt(10)
    s_barrier
    s_cmp_ge_u32 s21, s28
    s_addc_u32 s53, s21, 0
    s_add_u32 s21, s21, 1
    s_lshr_b32 s20, s53, 1
    s_mul_i32 s20, s20, 9
    s_bitcmp1_b32 s53, 0
    s_cselect_b32 s52, 5, 0
    s_add_u32 s20, s20, s52
    s_add_u32 s20, s20, s29
    s_mul_i32 s40, s20, 36864
    s_add_u32 s40, s40, s22
    s_add_u32 s41, s40, 9216
    s_lshl_b32 s45, s20, 10
    s_add_u32 s45, s45, s23
    s_add_u32 m0, s42, 0
    s_nop 0
    buffer_load_dwordx4 v4, s[16:19], s40 offen  lds
    s_add_u32 m0, s42, 1024
    s_nop 0
    buffer_load_dwordx4 v5, s[16:19], s40 offen  lds
    s_add_u32 m0, s42, 2048
    s_nop 0
    buffer_load_dwordx4 v6, s[16:19], s40 offen  lds
    s_add_u32 m0, s42, 3072
    s_nop 0
    buffer_load_dwordx4 v4, s[16:19], s41 offen  lds
    s_add_u32 m0, s42, 4096
    s_nop 0
    buffer_load_dwordx4 v5, s[16:19], s41 offen  lds
    s_add_u32 m0, s42, 5120
    s_nop 0
    buffer_load_dwordx4 v6, s[16:19], s41 offen  lds
    s_add_u32 m0, s46, 0
    s_nop 0
    buffer_load_dwordx4 v8, s[24:27], s45 offen sc1 lds
    s_add_u32 m0, s46, 1024
    s_nop 0
    buffer_load_dwordx4 v9, s[24:27], s45 offen sc1 lds
    s_add_u32 m0, s46, 2048
    s_nop 0
    buffer_load_dwordx4 v10, s[24:27], s45 offen sc1 lds
    s_add_u32 m0, s46, 3072
    s_nop 0
    buffer_load_dwordx4 v11, s[24:27], s45 offen sc1 lds
    s_add_u32 s42, s42, 40960
    s_add_u32 s46, s46, 40960
    s_cmp_ge_u32 s42, 163840
    s_cselect_b32 s52, 163840, 0
    s_sub_u32 s42, s42, s52
    s_sub_u32 s46, s46, s52
    s_sub_u32 s43, s43, 1
    s_cmp_lg_u32 s43, 0
    s_cbranch_scc1 K2_LL1
    s_add_u32 s57, s57, 8192
    s_waitcnt vmcnt(10)
    s_barrier
    buffer_load_dword v16, v20, s[24:27], s57 offen sc1
    s_cmp_ge_u32 s21, s28
    s_addc_u32 s53, s21, 0
    s_add_u32 s21, s21, 1
    s_lshr_b32 s20, s53, 1
    s_mul_i32 s20, s20, 9
    s_bitcmp1_b32 s53, 0
    s_cselect_b32 s52, 5, 0
    s_add_u32 s20, s20, s52
    s_add_u32 s20, s20, s29
    s_mul_i32 s40, s20, 36864
    s_add_u32 s40, s40, s22
    s_add_u32 s41, s40, 9216
    s_lshl_b32 s45, s20, 10
    s_add_u32 s45, s45, s23
    s_add_u32 m0, s42, 0
    s_nop 0
    buffer_load_dwordx4 v4, s[16:19], s40 offen  lds
    s_add_u32 m0, s42, 1024
    s_nop 0
    buffer_load_dwordx4 v5, s[16:19], s40 offen  lds
    s_add_u32 m0, s42, 2048
    s_nop 0
    buffer_load_dwordx4 v6, s[16:19], s40 offen  lds
    s_add_u32 m0, s42, 3072
    s_nop 0
    buffer_load_dwordx4 v4, s[16:19], s41 offen  lds
    s_add_u32 m0, s42, 4096
    s_nop 0
    buffer_load_dwordx4 v5, s[16:19], s41 offen  lds
    s_add_u32 m0, s42, 5120
    s_nop 0
    buffer_load_dwordx4 v6, s[16:19], s41 offen  lds
    s_add_u32 m0, s46, 0
    s_nop 0
    buffer_load_dwordx4 v8, s[24:27], s45 offen sc1 lds
    s_add_u32 m0, s46, 1024
    s_nop 0
    buffer_load_dwordx4 v9, s[24:27], s45 offen sc1 lds
    s_add_u32 m0, s46, 2048
    s_nop 0
    buffer_load_dwordx4 v10, s[24:27], s45 offen sc1 lds
    s_add_u32 m0, s46, 3072
    s_nop 0
    buffer_load_dwordx4 v11, s[24:27], s45 offen sc1 lds
    s_add_u32 s42, s42, 40960
    s_add_u32 s46, s46, 40960
    s_cmp_ge_u32 s42, 163840
    s_cselect_b32 s52, 163840, 0
    s_sub_u32 s42, s42, s52
    s_sub_u32 s46, s46, s52
    s_waitcnt vmcnt(10)
    s_cmp_lg_u32 s36, 4
    s_cbranch_scc1 K2_H2_OK
    s_mov_b32 s47, 65536
    s_branch K2_H2_C
    s_mov_b32 s47, 65536
K2_H2:
    buffer_load_dword v16, v20, s[24:27], s57 offen sc1
    s_waitcnt vmcnt(0)
K2_H2_C:
    v_xor_b32 v16, s62, v16
    v_cmp_ne_u32 vcc, 0, v16
    s_cbranch_vccz K2_H2_OK
    s_sleep 8
    s_sub_u32 s47, s47, 1
    s_cmp_lg_u32 s47, 0
    s_cbranch_scc1 K2_H2
K2_H2_OK:
    s_barrier
    s_cmp_ge_u32 s21, s28
    s_addc_u32 s53, s21, 0
    s_add_u32 s21, s21, 1
    s_lshr_b32 s20, s53, 1
    s_mul_i32 s20, s20, 9
    s_bitcmp1_b32 s53, 0
    s_cselect_b32 s52, 5, 0
    s_add_u32 s20, s20, s52
    s_add_u32 s20, s20, s29
    s_mul_i32 s40, s20, 36864
    s_add_u32 s40, s40, s22
    s_add_u32 s41, s40, 9216
    s_lshl_b32 s45, s20, 10
    s_add_u32 s45, s45, s23
    s_add_u32 m0, s42, 0
    s_nop 0
    buffer_load_dwordx4 v4, s[16:19], s40 offen  lds
    s_add_u32 m0, s42, 1024
    s_nop 0
    buffer_load_dwordx4 v5, s[16:19], s40 offen  lds
    s_add_u32 m0, s42, 2048
    s_nop 0
    buffer_load_dwordx4 v6, s[16:19], s40 offen  lds
    s_add_u32 m0, s42, 3072
    s_nop 0
    buffer_load_dwordx4 v4, s[16:19], s41 offen  lds
    s_add_u32 m0, s42, 4096
    s_nop 0
    buffer_load_dwordx4 v5, s[16:19], s41 offen  lds
    s_add_u32 m0, s42, 5120
    s_nop 0
    buffer_load_dwordx4 v6, s[16:19], s41 offen  lds
    s_add_u32 m0, s46, 0
    s_nop 0
    buffer_load_dwordx4 v8, s[24:27], s45 offen sc1 lds
    s_add_u32 m0, s46, 1024
    s_nop 0
    buffer_load_dwordx4 v9, s[24:27], s45 offen sc1 lds
    s_add_u32 m0, s46, 2048
    s_nop 0
    buffer_load_dwordx4 v10, s[24:27], s45 offen sc1 lds
    s_add_u32 m0, s46, 3072
    s_nop 0
    buffer_load_dwordx4 v11, s[24:27], s45 offen sc1 lds
    s_add_u32 s42, s42, 40960
    s_add_u32 s46, s46, 40960
    s_cmp_ge_u32 s42, 163840
    s_cselect_b32 s52, 163840, 0
    s_sub_u32 s42, s42, s52
    s_sub_u32 s46, s46, s52
    s_waitcnt vmcnt(10)
    s_barrier
    s_cmp_ge_u32 s21, s28
    s_addc_u32 s53, s21, 0
    s_add_u32 s21, s21, 1
    s_lshr_b32 s20, s53, 1
    s_mul_i32 s20, s20, 9
    s_bitcmp1_b32 s53, 0
    s_cselect_b32 s52, 5, 0
    s_add_u32 s20, s20, s52
    s_add_u32 s20, s20, s29
    s_mul_i32 s40, s20, 36864
    s_add_u32 s40, s40, s22
    s_add_u32 s41, s40, 9216
    s_lshl_b32 s45, s20, 10
    s_add_u32 s45, s45, s23
    s_add_u32 m0, s42, 0
    s_nop 0
    buffer_load_dwordx4 v4, s[16:19], s40 offen  lds
    s_add_u32 m0, s42, 1024
    s_nop 0
    buffer_load_dwordx4 v5, s[16:19], s40 offen  lds
    s_add_u32 m0, s42, 2048
    s_nop 0
    buffer_load_dwordx4 v6, s[16:19], s40 offen  lds
    s_add_u32 m0, s42, 3072
    s_nop 0
    buffer_load_dwordx4 v4, s[16:19], s41 offen  lds
    s_add_u32 m0, s42, 4096
    s_nop 0
    buffer_load_dwordx4 v5, s[16:19], s41 offen  lds
    s_add_u32 m0, s42, 5120
    s_nop 0
    buffer_load_dwordx4 v6, s[16:19], s41 offen  lds
    s_add_u32 m0, s46, 0
    s_nop 0
    buffer_load_dwordx4 v8, s[24:27], s45 offen sc1 lds
    s_add_u32 m0, s46, 1024
    s_nop 0
    buffer_load_dwordx4 v9, s[24:27], s45 offen sc1 lds
    s_add_u32 m0, s46, 2048
    s_nop 0
    buffer_load_dwordx4 v10, s[24:27], s45 offen sc1 lds
    s_add_u32 m0, s46, 3072
    s_nop 0
    buffer_load_dwordx4 v11, s[24:27], s45 offen sc1 lds
    s_add_u32 s42, s42, 40960
    s_add_u32 s46, s46, 40960
    s_cmp_ge_u32 s42, 163840
    s_cselect_b32 s52, 163840, 0
    s_sub_u32 s42, s42, s52
    s_sub_u32 s46, s46, s52
    s_waitcnt vmcnt(10)
    s_lshr_b32 s20, s54, 1
    s_mul_i32 s20, s20, 9
    s_add_u32 s20, s20, 4
    s_barrier
    s_mul_i32 s40, s20, 36864
    s_add_u32 s40, s40, s22
    s_add_u32 s41, s40, 9216
    s_lshl_b32 s45, s20, 10
    s_add_u32 s45, s45, s23
    s_add_u32 m0, s42, 0
    s_nop 0
    buffer_load_dwordx4 v4, s[16:19], s40 offen  lds
    s_add_u32 m0, s42, 1024
    s_nop 0
    buffer_load_dwordx4 v5, s[16:19], s40 offen  lds
    s_add_u32 m0, s42, 2048
    s_nop 0
    buffer_load_dwordx4 v6, s[16:19], s40 offen  lds
    s_add_u32 m0, s42, 3072
    s_nop 0
    buffer_load_dwordx4 v4, s[16:19], s41 offen  lds
    s_add_u32 m0, s42, 4096
    s_nop 0
    buffer_load_dwordx4 v5, s[16:19], s41 offen  lds
    s_add_u32 m0, s42, 5120
    s_nop 0
    buffer_load_dwordx4 v6, s[16:19], s41 offen  lds
    s_add_u32 m0, s46, 0
    s_nop 0
    buffer_load_dwordx4 v8, s[24:27], s45 offen sc1 lds
    s_add_u32 m0, s46, 1024
    s_nop 0
    buffer_load_dwordx4 v9, s[24:27], s45 offen sc1 lds
    s_add_u32 m0, s46, 2048
    s_nop 0
    buffer_load_dwordx4 v10, s[24:27], s45 offen sc1 lds
    s_add_u32 m0, s46, 3072
    s_nop 0
    buffer_load_dwordx4 v11, s[24:27], s45 offen sc1 lds
    s_add_u32 s20, s20, 18
    s_add_u32 s42, s42, 40960
    s_add_u32 s46, s46, 40960
    s_cmp_ge_u32 s42, 163840
    s_cselect_b32 s52, 163840, 0
    s_sub_u32 s42, s42, s52
    s_sub_u32 s46, s46, s52
    s_waitcnt vmcnt(10)
    s_barrier
    buffer_load_dword v16, v14, s[24:27], s55 offen sc1
    s_mul_i32 s40, s20, 36864
    s_add_u32 s40, s40, s22
    s_add_u32 s41, s40, 9216
    s_lshl_b32 s45, s20, 10
    s_add_u32 s45, s45, s23
    s_add_u32 m0, s42, 0
    s_nop 0
    buffer_load_dwordx4 v4, s[16:19], s40 offen  lds
    s_add_u32 m0, s42, 1024
    s_nop 0
    buffer_load_dwordx4 v5, s[16:19], s40 offen  lds
    s_add_u32 m0, s42, 2048
    s_nop 0
    buffer_load_dwordx4 v6, s[16:19], s40 offen  lds
    s_add_u32 m0, s42, 3072
    s_nop 0
    buffer_load_dwordx4 v4, s[16:19], s41 offen  lds
    s_add_u32 m0, s42, 4096
    s_nop 0
    buffer_load_dwordx4 v5, s[16:19], s41 offen  lds
    s_add_u32 m0, s42, 5120
    s_nop 0
    buffer_load_dwordx4 v6, s[16:19], s41 offen  lds
    s_add_u32 m0, s46, 0
    s_nop 0
    buffer_load_dwordx4 v8, s[24:27], s45 offen sc1 lds
    s_add_u32 m0, s46, 1024
    s_nop 0
    buffer_load_dwordx4 v9, s[24:27], s45 offen sc1 lds
    s_add_u32 m0, s46, 2048
    s_nop 0
    buffer_load_dwordx4 v10, s[24:27], s45 offen sc1 lds
    s_add_u32 m0, s46, 3072
    s_nop 0
    buffer_load_dwordx4 v11, s[24:27], s45 offen sc1 lds
    s_add_u32 s20, s20, 18
    s_add_u32 s42, s42, 40960
    s_add_u32 s46, s46, 40960
    s_cmp_ge_u32 s42, 163840
    s_cselect_b32 s52, 163840, 0
    s_sub_u32 s42, s42, s52
    s_sub_u32 s46, s46, s52
    s_waitcnt vmcnt(10)
    s_cmp_lg_u32 s36, 4
    s_cbranch_scc1 K2_ZSP_OK
    s_mov_b32 s47, 65536
    s_branch K2_ZSP_C
    s_mov_b32 s47, 65536
K2_ZSP:
    buffer_load_dword v16, v14, s[24:27], s55 offen sc1
    s_waitcnt vmcnt(0)
K2_ZSP_C:
    v_xor_b32 v16, s62, v16
    v_cmp_ne_u32 vcc, 0, v16
    s_cbranch_vccz K2_ZSP_OK
    s_sleep 8
    s_sub_u32 s47, s47, 1
    s_cmp_lg_u32 s47, 0
    s_cbranch_scc1 K2_ZSP
K2_ZSP_OK:
    s_barrier
    s_add_u32 s41, s61, 9216
    s_add_u32 s40, s60, 33792
    s_add_u32 m0, s42, 0
    s_nop 0
    buffer_load_dwordx4 v4, s[24:27], s61 offen lds
    s_add_u32 m0, s42, 1024
    s_nop 0
    buffer_load_dwordx4 v5, s[24:27], s61 offen lds
    s_add_u32 m0, s42, 2048
    s_nop 0
    buffer_load_dwordx4 v6, s[24:27], s61 offen lds
    s_add_u32 m0, s42, 3072
    s_nop 0
    buffer_load_dwordx4 v4, s[24:27], s41 offen lds
    s_add_u32 m0, s42, 4096
    s_nop 0
    buffer_load_dwordx4 v5, s[24:27], s41 offen lds
    s_add_u32 m0, s42, 5120
    s_nop 0
    buffer_load_dwordx4 v6, s[24:27], s41 offen lds
    s_add_u32 m0, s46, 0
    s_nop 0
    buffer_load_dwordx4 v12, s[24:27], s60 offen sc1 lds
    s_add_u32 m0, s46, 1024
    s_nop 0
    buffer_load_dwordx4 v13, s[24:27], s60 offen sc1 lds
    s_add_u32 m0, s46, 2048
    s_nop 0
    buffer_load_dwordx4 v12, s[24:27], s40 offen sc1 lds
    s_add_u32 m0, s46, 3072
    s_nop 0
    buffer_load_dwordx4 v13, s[24:27], s40 offen sc1 lds
    s_add_u32 s61, s61, 73728
    s_add_u32 s60, s60, 270336
    s_add_u32 s42, s42, 40960
    s_add_u32 s46, s46, 40960
    s_cmp_ge_u32 s42, 163840
    s_cselect_b32 s52, 163840, 0
    s_sub_u32 s42, s42, s52
    s_sub_u32 s46, s46, s52
    s_waitcnt vmcnt(10)
    s_barrier
    s_add_u32 s41, s61, 9216
    s_add_u32 s40, s60, 33792
    s_add_u32 m0, s42, 0
    s_nop 0
    buffer_load_dwordx4 v4, s[24:27], s61 offen lds
    s_add_u32 m0, s42, 1024
    s_nop 0
    buffer_load_dwordx4 v5, s[24:27], s61 offen lds
    s_add_u32 m0, s42, 2048
    s_nop 0
    buffer_load_dwordx4 v6, s[24:27], s61 offen lds
    s_add_u32 m0, s42, 3072
    s_nop 0
    buffer_load_dwordx4 v4, s[24:27], s41 offen lds
    s_add_u32 m0, s42, 4096
    s_nop 0
    buffer_load_dwordx4 v5, s[24:27], s41 offen lds
    s_add_u32 m0, s42, 5120
    s_nop 0
    buffer_load_dwordx4 v6, s[24:27], s41 offen lds
    s_add_u32 m0, s46, 0
    s_nop 0
    buffer_load_dwordx4 v12, s[24:27], s60 offen sc1 lds
    s_add_u32 m0, s46, 1024
    s_nop 0
    buffer_load_dwordx4 v13, s[24:27], s60 offen sc1 lds
    s_add_u32 m0, s46, 2048
    s_nop 0
    buffer_load_dwordx4 v12, s[24:27], s40 offen sc1 lds
    s_add_u32 m0, s46, 3072
    s_nop 0
    buffer_load_dwordx4 v13, s[24:27], s40 offen sc1 lds
    s_add_u32 s61, s61, 73728
    s_add_u32 s60, s60, 270336
    s_add_u32 s42, s42, 40960
    s_add_u32 s46, s46, 40960
    s_cmp_ge_u32 s42, 163840
    s_cselect_b32 s52, 163840, 0
    s_sub_u32 s42, s42, s52
    s_sub_u32 s46, s46, s52
    s_waitcnt vmcnt(10)
    s_barrier
    s_cmp_eq_u32 s36, 4
    s_cselect_b32 s61, s61, 0x40000000
    s_cselect_b32 s60, s60, 0x40000000
    s_add_u32 s41, s61, 9216
    s_add_u32 s40, s60, 33792
    s_add_u32 m0, s42, 0
    s_nop 0
    buffer_load_dwordx4 v4, s[24:27], s61 offen lds
    s_add_u32 m0, s42, 1024
    s_nop 0
    buffer_load_dwordx4 v5, s[24:27], s61 offen lds
    s_add_u32 m0, s42, 2048
    s_nop 0
    buffer_load_dwordx4 v6, s[24:27], s61 offen lds
    s_add_u32 m0, s42, 3072
    s_nop 0
    buffer_load_dwordx4 v4, s[24:27], s41 offen lds
    s_add_u32 m0, s42, 4096
    s_nop 0
    buffer_load_dwordx4 v5, s[24:27], s41 offen lds
    s_add_u32 m0, s42, 5120
    s_nop 0
    buffer_load_dwordx4 v6, s[24:27], s41 offen lds
    s_add_u32 m0, s46, 0
    s_nop 0
    buffer_load_dwordx4 v12, s[24:27], s60 offen sc1 lds
    s_add_u32 m0, s46, 1024
    s_nop 0
    buffer_load_dwordx4 v13, s[24:27], s60 offen sc1 lds
    s_add_u32 m0, s46, 2048
    s_nop 0
    buffer_load_dwordx4 v12, s[24:27], s40 offen sc1 lds
    s_add_u32 m0, s46, 3072
    s_nop 0
    buffer_load_dwordx4 v13, s[24:27], s40 offen sc1 lds
    s_add_u32 s61, s61, 73728
    s_add_u32 s60, s60, 270336
    s_add_u32 s42, s42, 40960
    s_add_u32 s46, s46, 40960
    s_cmp_ge_u32 s42, 163840
    s_cselect_b32 s52, 163840, 0
    s_sub_u32 s42, s42, s52
    s_sub_u32 s46, s46, s52
    s_waitcnt vmcnt(10)
    s_barrier
    s_waitcnt vmcnt(0)
    s_barrier
    s_barrier
K2_RED:
    s_mul_i32 s52, s38, 3
    s_add_u32 s52, s52, s39
    s_lshl_b32 s52, s52, 9
    s_add_u32 s52, s52, 36988160
    s_cmp_lg_u32 s36, 7
    s_cbranch_scc1 K2_RED1
    s_lshl_b32 s53, s37, 7
    s_add_u32 s53, s53, s52
    v_mov_b32 v16, s62
    v_mov_b32 v17, 0
    s_mov_b64 exec, 1
    buffer_store_dword v16, v17, s[24:27], s53 offen sc1
    s_mov_b64 exec, -1
    v_mov_b32 v21, 0
    v_and_b32 v21, 3, v1
    v_max_u32 v21, 1, v21
    v_xor_b32 v21, s37, v21
    v_lshlrev_b32 v21, 7, v21
    s_mov_b32 s47, 65536
K2_RSP:
    buffer_load_dword v16, v21, s[24:27], s52 offen sc1
    s_waitcnt vmcnt(0)
K2_RSP_C:
    v_xor_b32 v16, s62, v16
    v_cmp_ne_u32 vcc, 0, v16
    s_cbranch_vccz K2_RSP_OK
    s_sleep 1
    s_sub_u32 s47, s47, 1
    s_cmp_lg_u32 s47, 0
    s_cbranch_scc1 K2_RSP
K2_RSP_OK:
K2_RED1:
    s_lshl_b32 s53, s38, 2
    s_add_u32 s53, s53, s37
    s_mul_i32 s54, s39, 6
    s_add_u32 s54, s54, s36
    s_mul_i32 s55, s53, 38912
    s_lshl_b32 s56, s54, 10
    s_add_u32 s55, s55, s56
    s_add_u32 s55, s55, 26312960
    s_mul_i32 s56, s53, 1152
    s_lshl_b32 s57, s54, 6
    s_add_u32 s56, s56, s57
    v_and_b32 v21, 15, v1
    s_mov_b32 s57, 73728
    v_mul_lo_u32 v20, v21, s57
    v_bfe_u32 v21, v1, 4, 1
    v_lshl_add_u32 v20, v21, 5, v20
    v_lshrrev_b32 v21, 5, v1
    v_lshl_add_u32 v20, v21, 4, v20
    s_mov_b32 s32, s100
    s_and_b32 s33, s101, 0xffff
    s_mov_b32 s34, 0x240000
    s_mov_b32 s35, 0x20000
    s_barrier
    s_cmp_ge_u32 s36, 6
    s_cbranch_scc1 K2_FIN
    s_add_u32 s57, s55, 0
    buffer_load_dwordx4 v[32:35], v2, s[24:27], s57 offen sc1
    s_add_u32 s57, s55, 2490368
    buffer_load_dwordx4 v[36:39], v2, s[24:27], s57 offen sc1
    s_add_u32 s57, s55, 4980736
    buffer_load_dwordx4 v[40:43], v2, s[24:27], s57 offen sc1
    s_add_u32 s57, s55, 7471104
    buffer_load_dwordx4 v[44:47], v2, s[24:27], s57 offen sc1
    s_add_u32 s57, s55, 19456
    buffer_load_dwordx4 v[48:51], v2, s[24:27], s57 offen sc1
    s_add_u32 s57, s55, 2509824
    buffer_load_dwordx4 v[52:55], v2, s[24:27], s57 offen sc1
    s_add_u32 s57, s55, 5000192
    buffer_load_dwordx4 v[56:59], v2, s[24:27], s57 offen sc1
    s_add_u32 s57, s55, 7490560
    buffer_load_dwordx4 v[60:63], v2, s[24:27], s57 offen sc1
    s_waitcnt vmcnt(7)
    v_lshlrev_b32 v64, 16, v32
    v_and_b32 v65, 0xffff0000, v32
    v_lshlrev_b32 v66, 16, v33
    v_and_b32 v67, 0xffff0000, v33
    v_lshlrev_b32 v68, 16, v34
    v_and_b32 v69, 0xffff0000, v34
    v_lshlrev_b32 v70, 16, v35
    v_and_b32 v71, 0xffff0000, v35
    s_waitcnt vmcnt(6)
    v_lshlrev_b32 v72, 16, v36
    v_and_b32 v73, 0xffff0000, v36
    v_lshlrev_b32 v74, 16, v37
    v_and_b32 v75, 0xffff0000, v37
    v_lshlrev_b32 v76, 16, v38
    v_and_b32 v77, 0xffff0000, v38
    v_lshlrev_b32 v78, 16, v39
    v_and_b32 v79, 0xffff0000, v39
    v_pk_add_f32 v[64:65], v[64:65], v[72:73]
    v_pk_add_f32 v[66:67], v[66:67], v[74:75]
    v_pk_add_f32 v[68:69], v[68:69], v[76:77]
    v_pk_add_f32 v[70:71], v[70:71], v[78:79]
    s_waitcnt vmcnt(5)
    v_lshlrev_b32 v72, 16, v40
    v_and_b32 v73, 0xffff0000, v40
    v_lshlrev_b32 v74, 16, v41
    v_and_b32 v75, 0xffff0000, v41
    v_lshlrev_b32 v76, 16, v42
    v_and_b32 v77, 0xffff0000, v42
    v_lshlrev_b32 v78, 16, v43
    v_and_b32 v79, 0xffff0000, v43
    v_pk_add_f32 v[64:65], v[64:65], v[72:73]
    v_pk_add_f32 v[66:67], v[66:67], v[74:75]
    v_pk_add_f32 v[68:69], v[68:69], v[76:77]
    v_pk_add_f32 v[70:71], v[70:71], v[78:79]
    s_waitcnt vmcnt(4)
    v_lshlrev_b32 v72, 16, v44
    v_and_b32 v73, 0xffff0000, v44
    v_lshlrev_b32 v74, 16, v45
    v_and_b32 v75, 0xffff0000, v45
    v_lshlrev_b32 v76, 16, v46
    v_and_b32 v77, 0xffff0000, v46
    v_lshlrev_b32 v78, 16, v47
    v_and_b32 v79, 0xffff0000, v47
    v_pk_add_f32 v[64:65], v[64:65], v[72:73]
    v_pk_add_f32 v[66:67], v[66:67], v[74:75]
    v_pk_add_f32 v[68:69], v[68:69], v[76:77]
    v_pk_add_f32 v[70:71], v[70:71], v[78:79]
    v_cvt_pk_bf16_f32 v72, v64, v65
    v_cvt_pk_bf16_f32 v73, v66, v67
    v_cvt_pk_bf16_f32 v74, v68, v69
    v_cvt_pk_bf16_f32 v75, v70, v71
    s_nop 1
    v_permlane16_swap_b32 v72, v74
    v_permlane16_swap_b32 v73, v75
    s_add_u32 s57, s56, 0
    buffer_store_dwordx4 v[72:75], v20, s[32:35], s57 offen
    s_waitcnt vmcnt(4)
    v_lshlrev_b32 v80, 16, v48
    v_and_b32 v81, 0xffff0000, v48
    v_lshlrev_b32 v82, 16, v49
    v_and_b32 v83, 0xffff0000, v49
    v_lshlrev_b32 v84, 16, v50
    v_and_b32 v85, 0xffff0000, v50
    v_lshlrev_b32 v86, 16, v51
    v_and_b32 v87, 0xffff0000, v51
    s_waitcnt vmcnt(3)
    v_lshlrev_b32 v88, 16, v52
    v_and_b32 v89, 0xffff0000, v52
    v_lshlrev_b32 v90, 16, v53
    v_and_b32 v91, 0xffff0000, v53
    v_lshlrev_b32 v92, 16, v54
    v_and_b32 v93, 0xffff0000, v54
    v_lshlrev_b32 v94, 16, v55
    v_and_b32 v95, 0xffff0000, v55
    v_pk_add_f32 v[80:81], v[80:81], v[88:89]
    v_pk_add_f32 v[82:83], v[82:83], v[90:91]
    v_pk_add_f32 v[84:85], v[84:85], v[92:93]
    v_pk_add_f32 v[86:87], v[86:87], v[94:95]
    s_waitcnt vmcnt(2)
    v_lshlrev_b32 v88, 16, v56
    v_and_b32 v89, 0xffff0000, v56
    v_lshlrev_b32 v90, 16, v57
    v_and_b32 v91, 0xffff0000, v57
    v_lshlrev_b32 v92, 16, v58
    v_and_b32 v93, 0xffff0000, v58
    v_lshlrev_b32 v94, 16, v59
    v_and_b32 v95, 0xffff0000, v59
    v_pk_add_f32 v[80:81], v[80:81], v[88:89]
    v_pk_add_f32 v[82:83], v[82:83], v[90:91]
    v_pk_add_f32 v[84:85], v[84:85], v[92:93]
    v_pk_add_f32 v[86:87], v[86:87], v[94:95]
    s_waitcnt vmcnt(1)
    v_lshlrev_b32 v88, 16, v60
    v_and_b32 v89, 0xffff0000, v60
    v_lshlrev_b32 v90, 16, v61
    v_and_b32 v91, 0xffff0000, v61
    v_lshlrev_b32 v92, 16, v62
    v_and_b32 v93, 0xffff0000, v62
    v_lshlrev_b32 v94, 16, v63
    v_and_b32 v95, 0xffff0000, v63
    v_pk_add_f32 v[80:81], v[80:81], v[88:89]
    v_pk_add_f32 v[82:83], v[82:83], v[90:91]
    v_pk_add_f32 v[84:85], v[84:85], v[92:93]
    v_pk_add_f32 v[86:87], v[86:87], v[94:95]
    v_cvt_pk_bf16_f32 v88, v80, v81
    v_cvt_pk_bf16_f32 v89, v82, v83
    v_cvt_pk_bf16_f32 v90, v84, v85
    v_cvt_pk_bf16_f32 v91, v86, v87
    s_nop 1
    v_permlane16_swap_b32 v88, v90
    v_permlane16_swap_b32 v89, v91
    s_add_u32 s57, s56, 1179648
    buffer_store_dwordx4 v[88:91], v20, s[32:35], s57 offen
    s_branch K2_FIN
K2_FFT:
    s_sub_u32 s37, s53, 24
    s_lshl_b32 s37, s37, 3
    s_add_u32 s37, s37, s52
    s_lshl_b32 s38, s36, 6
    s_add_u32 s38, s38, s37
    v_and_b32 v3, 31, v1
    v_lshrrev_b32 v4, 5, v1
    v_lshrrev_b32 v10, 4, v1
    v_xor_b32 v10, v10, v1
    v_and_b32 v11, 7, v10
    v_and_b32 v10, 56, v1
    v_or_b32 v10, v10, v11
    v_lshlrev_b32 v10, 4, v10
    v_xor_b32 v11, 64, v10
    v_bfe_u32 v12, v1, 1, 3
    v_xor_b32 v12, v12, v4
    v_lshlrev_b32 v12, 4, v12
    v_lshl_add_u32 v12, v3, 7, v12
    s_lshl_b32 s56, s36, 13
    s_add_u32 s56, s56, 81920
    v_add_u32 v12, s56, v12
    v_cvt_f32_u32 v3, v3
    v_cvt_f32_u32 v4, v4
    s_cmp_lt_u32 s36, 4
    s_cbranch_scc1 K2_FM
    v_mov_b32 v224, v176
    v_mov_b32 v225, v177
    v_mov_b32 v226, v178
    v_mov_b32 v227, v179
    v_mov_b32 v228, v180
    v_mov_b32 v229, v181
    v_mov_b32 v230, v182
    v_mov_b32 v231, v183
    v_mov_b32 v232, v184
    v_mov_b32 v233, v185
    v_mov_b32 v234, v186
    v_mov_b32 v235, v187
    v_mov_b32 v236, v188
    v_mov_b32 v237, v189
    v_mov_b32 v238, v190
    v_mov_b32 v239, v191
K2_FM:
    v_mov_b32 v6, 40960
    v_mov_b32 v7, 0
    ds_write_b32 v6, v7
    s_mov_b32 s58, 36954368
    s_mov_b32 s59, 36958464
    s_cmp_lg_u32 s36, 7
    s_cbranch_scc1 K2_FA
    buffer_load_dwordx4 v[16:19], v2, s[24:27], s58 offen offset:0 sc1
    buffer_load_dwordx4 v[20:23], v2, s[24:27], s58 offen offset:1024 sc1
    buffer_load_dwordx4 v[24:27], v2, s[24:27], s58 offen offset:2048 sc1
    buffer_load_dwordx4 v[28:31], v2, s[24:27], s58 offen offset:3072 sc1
    buffer_load_dwordx4 v[32:35], v2, s[24:27], s59 offen offset:0 sc1
    buffer_load_dwordx4 v[36:39], v2, s[24:27], s59 offen offset:1024 sc1
    buffer_load_dwordx4 v[40:43], v2, s[24:27], s59 offen offset:2048 sc1
    buffer_load_dwordx4 v[44:47], v2, s[24:27], s59 offen offset:3072 sc1
K2_FA:
    s_cmp_gt_u32 s38, 288
    s_cbranch_scc1 K2_FT
    s_cmp_eq_u32 s38, 288
    s_cselect_b32 s20, 0, s38
    s_lshr_b32 s21, s20, 7
    s_lshl_b32 s21, s21, 8
    s_bfe_u32 s20, s20, 0x30004
    s_lshl_b32 s20, s20, 4
    s_add_u32 s20, s20, s21
    s_add_u32 s20, s20, 36954376
    s_mul_i32 s21, s38, 898
    s_lshr_b32 s21, s21, 16
    s_and_b32 s22, s21, 1
    s_lshl_b32 s22, s22, 12
    s_lshr_b32 s21, s21, 1
    s_lshl_b32 s21, s21, 8
    s_add_u32 s21, s21, s22
    s_add_u32 s21, s21, 36954368
    v_bfe_u32 v28, v1, 2, 3
    v_lshlrev_b32 v28, 10, v28
    v_bfe_u32 v29, v1, 1, 1
    v_lshl_add_u32 v28, v29, 7, v28
    v_and_b32 v29, 1, v1
    v_lshl_add_u32 v28, v29, 2, v28
    v_lshrrev_b32 v29, 4, v1
    v_lshlrev_b32 v29, 10, v29
    v_and_b32 v30, 15, v1
    v_lshl_add_u32 v29, v30, 4, v29
    buffer_load_dword v24, v28, s[24:27], s20 offen sc1
    buffer_load_dwordx4 v[16:19], v29, s[24:27], s21 offen sc1
    buffer_load_dwordx4 v[20:23], v29, s[24:27], s21 offen offset:512 sc1
K2_FT:
    s_lshr_b32 s52, s36, 2
    s_bfe_u32 s53, s36, 0x10001
    s_lshl_b32 s53, s53, 5
    s_and_b32 s54, s36, 1
    s_lshl_b32 s54, s54, 4
    s_cmp_eq_u32 s52, 0
    s_cselect_b32 s55, 0, s53
    s_cselect_b32 s53, s53, 0
    s_add_u32 s54, s54, s53
    v_cvt_f32_u32 v48, s55
    v_add_f32 v48, v48, v3
    v_mul_f32 v48, 0x3a000000, v48
    v_cvt_f32_u32 v49, s54
    v_fma_f32 v49, v4, 4.0, v49
    v_mul_f32 v49, v48, v49
    s_cmp_eq_u32 s52, 0
    s_cselect_b32 s53, 0x3f800000, 0x35e38e39
    s_mov_b32 s54, 0x00000000
    v_fma_f32 v52, v48, s54, v49
    s_mov_b32 s54, 0x3f800000
    v_fma_f32 v54, v48, s54, v49
    s_mov_b32 s54, 0x40000000
    v_fma_f32 v56, v48, s54, v49
    s_mov_b32 s54, 0x40400000
    v_fma_f32 v58, v48, s54, v49
    s_mov_b32 s54, 0x41000000
    v_fma_f32 v60, v48, s54, v49
    s_mov_b32 s54, 0x41100000
    v_fma_f32 v62, v48, s54, v49
    s_mov_b32 s54, 0x41200000
    v_fma_f32 v64, v48, s54, v49
    s_mov_b32 s54, 0x41300000
    v_fma_f32 v66, v48, s54, v49
    v_sin_f32 v53, v52
    v_cos_f32 v52, v52
    v_sin_f32 v55, v54
    v_cos_f32 v54, v54
    v_sin_f32 v57, v56
    v_cos_f32 v56, v56
    v_sin_f32 v59, v58
    v_cos_f32 v58, v58
    v_sin_f32 v61, v60
    v_cos_f32 v60, v60
    v_sin_f32 v63, v62
    v_cos_f32 v62, v62
    v_sin_f32 v65, v64
    v_cos_f32 v64, v64
    v_sin_f32 v67, v66
    v_cos_f32 v66, v66
    s_lshl_b32 s55, s36, 12
    v_add_u32 v50, s55, v2
    v_mul_f32 v52, s53, v52
    v_mul_f32 v53, s53, v53
    v_mul_f32 v54, s53, v54
    v_mul_f32 v55, s53, v55
    v_mul_f32 v56, s53, v56
    v_mul_f32 v57, s53, v57
    v_mul_f32 v58, s53, v58
    v_mul_f32 v59, s53, v59
    v_mul_f32 v60, s53, v60
    v_mul_f32 v61, s53, v61
    v_mul_f32 v62, s53, v62
    v_mul_f32 v63, s53, v63
    v_mul_f32 v64, s53, v64
    v_mul_f32 v65, s53, v65
    v_mul_f32 v66, s53, v66
    v_mul_f32 v67, s53, v67
    ds_write_b128 v50, v[52:55] offset:45056
    ds_write_b128 v50, v[56:59] offset:46080
    ds_write_b128 v50, v[60:63] offset:47104
    ds_write_b128 v50, v[64:67] offset:48128
    s_cmp_eq_u32 s38, 288
    s_cselect_b32 s52, 0, s38
    s_cmp_eq_u32 s52, 0
    s_cselect_b32 s39, 1, 0
    s_mul_i32 s52, s52, 8448
    s_add_u32 s52, s52, 19005440
    s_add_u32 s53, s52, 4096
    s_mul_i32 s54, s38, 8448
    s_add_u32 s54, s54, 21438464
    s_add_u32 s55, s54, 4096
    s_cmp_gt_u32 s38, 288
    s_cbranch_scc1 K2_FD0
    s_mov_b32 s47, 65536
    s_waitcnt vmcnt(0)
    s_branch K2_CSP_C
    s_mov_b32 s47, 65536
K2_CSP:
    buffer_load_dword v24, v28, s[24:27], s20 offen sc1
    buffer_load_dwordx4 v[16:19], v29, s[24:27], s21 offen sc1
    buffer_load_dwordx4 v[20:23], v29, s[24:27], s21 offen offset:512 sc1
    s_waitcnt vmcnt(0)
K2_CSP_C:
    v_xor_b32 v16, s62, v16
    v_xor_b32 v17, s62, v17
    v_or_b32 v16, v16, v17
    v_xor_b32 v18, s62, v18
    v_or_b32 v16, v16, v18
    v_xor_b32 v19, s62, v19
    v_or_b32 v16, v16, v19
    v_xor_b32 v20, s62, v20
    v_or_b32 v16, v16, v20
    v_xor_b32 v21, s62, v21
    v_or_b32 v16, v16, v21
    v_xor_b32 v22, s62, v22
    v_or_b32 v16, v16, v22
    v_xor_b32 v23, s62, v23
    v_or_b32 v16, v16, v23
    v_xor_b32 v24, s62, v24
    v_or_b32 v16, v16, v24
    v_cmp_ne_u32 vcc, 0, v16
    s_cbranch_vccz K2_CSP_OK
    s_sleep 2
    s_sub_u32 s47, s47, 1
    s_cmp_lg_u32 s47, 0
    s_cbranch_scc1 K2_CSP
K2_CSP_OK:
    s_lshl_b32 s56, s36, 13
    s_add_u32 m0, s56, 81920
    s_nop 0
    buffer_load_dwordx4 v10, s[24:27], s52 offen offset:0 sc1 lds
    s_add_u32 m0, s56, 81920
    s_nop 0
    buffer_load_dwordx4 v11, s[24:27], s52 offen offset:1024 sc1 lds
    s_add_u32 m0, s56, 81920
    s_nop 0
    buffer_load_dwordx4 v10, s[24:27], s52 offen offset:2048 sc1 lds
    s_add_u32 m0, s56, 81920
    s_nop 0
    buffer_load_dwordx4 v11, s[24:27], s52 offen offset:3072 sc1 lds
    s_add_u32 m0, s56, 86016
    s_nop 0
    buffer_load_dwordx4 v10, s[24:27], s53 offen offset:0 sc1 lds
    s_add_u32 m0, s56, 86016
    s_nop 0
    buffer_load_dwordx4 v11, s[24:27], s53 offen offset:1024 sc1 lds
    s_add_u32 m0, s56, 86016
    s_nop 0
    buffer_load_dwordx4 v10, s[24:27], s53 offen offset:2048 sc1 lds
    s_add_u32 m0, s56, 86016
    s_nop 0
    buffer_load_dwordx4 v11, s[24:27], s53 offen offset:3072 sc1 lds
    buffer_load_dwordx4 v[176:179], v2, s[24:27], s54 offen offset:0 sc1
    buffer_load_dwordx4 v[180:183], v2, s[24:27], s54 offen offset:1024 sc1
    buffer_load_dwordx4 v[184:187], v2, s[24:27], s54 offen offset:2048 sc1
    buffer_load_dwordx4 v[188:191], v2, s[24:27], s54 offen offset:3072 sc1
    buffer_load_dwordx4 v[192:195], v2, s[24:27], s55 offen offset:0 sc1
    buffer_load_dwordx4 v[196:199], v2, s[24:27], s55 offen offset:1024 sc1
    buffer_load_dwordx4 v[200:203], v2, s[24:27], s55 offen offset:2048 sc1
    buffer_load_dwordx4 v[204:207], v2, s[24:27], s55 offen offset:3072 sc1
K2_FD0:
    s_lshr_b32 s52, s36, 2
    s_lshl_b32 s52, s52, 5
    v_cvt_f32_u32 v48, s52
    v_add_f32 v48, v48, v3
    v_mul_f32 v48, 0x3c800000, v48
    s_and_b32 s53, s36, 3
    s_lshl_b32 s53, s53, 4
    v_cvt_f32_u32 v49, s53
    v_fma_f32 v49, v4, 4.0, v49
    s_lshl_b32 s55, s36, 10
    v_add_u32 v66, s55, v2
    v_mul_f32 v49, v48, v49
    s_mov_b32 s54, 0x00000000
    v_fma_f32 v50, v48, s54, v49
    s_mov_b32 s54, 0x3f800000
    v_fma_f32 v51, v48, s54, v49
    s_mov_b32 s54, 0x40000000
    v_fma_f32 v52, v48, s54, v49
    s_mov_b32 s54, 0x40400000
    v_fma_f32 v53, v48, s54, v49
    s_mov_b32 s54, 0x41000000
    v_fma_f32 v54, v48, s54, v49
    s_mov_b32 s54, 0x41100000
    v_fma_f32 v55, v48, s54, v49
    s_mov_b32 s54, 0x41200000
    v_fma_f32 v56, v48, s54, v49
    s_mov_b32 s54, 0x41300000
    v_fma_f32 v57, v48, s54, v49
    v_sin_f32 v58, v50
    v_cos_f32 v50, v50
    v_sin_f32 v59, v51
    v_cos_f32 v51, v51
    v_sin_f32 v60, v52
    v_cos_f32 v52, v52
    v_sin_f32 v61, v53
    v_cos_f32 v53, v53
    v_sin_f32 v62, v54
    v_cos_f32 v54, v54
    v_sin_f32 v63, v55
    v_cos_f32 v55, v55
    v_sin_f32 v64, v56
    v_cos_f32 v56, v56
    v_sin_f32 v65, v57
    v_cos_f32 v57, v57
    s_nop 0
    v_cvt_pk_bf16_f32 v68, v50, v51
    v_cvt_pk_bf16_f32 v72, v58, v59
    v_cvt_pk_bf16_f32 v69, v52, v53
    v_cvt_pk_bf16_f32 v73, v60, v61
    v_cvt_pk_bf16_f32 v70, v54, v55
    v_cvt_pk_bf16_f32 v74, v62, v63
    v_cvt_pk_bf16_f32 v71, v56, v57
    v_cvt_pk_bf16_f32 v75, v64, v65
    v_xor_b32 v76, 0x80008000, v72
    v_xor_b32 v77, 0x80008000, v73
    v_xor_b32 v78, 0x80008000, v74
    v_xor_b32 v79, 0x80008000, v75
    ds_write_b128 v66, v[68:71] offset:8192
    ds_write_b128 v66, v[72:75] offset:16384
    ds_write_b128 v66, v[76:79] offset:24576
    s_cmp_ge_u32 s36, 4
    s_cbranch_scc1 K2_J3
    v_mul_f32 v48, 0x3d000000, v3
    s_lshl_b32 s52, s36, 2
    v_cvt_f32_u32 v49, s52
    v_fma_f32 v49, v4, 2.0, v49
    v_mul_f32 v49, v48, v49
    s_mov_b32 s54, 0x00000000
    v_fma_f32 v50, v48, s54, v49
    s_mov_b32 s54, 0x41800000
    v_fma_f32 v51, v48, s54, v49
    s_mov_b32 s54, 0x3f800000
    v_fma_f32 v52, v48, s54, v49
    s_mov_b32 s54, 0x41880000
    v_fma_f32 v53, v48, s54, v49
    v_sin_f32 v58, v50
    v_cos_f32 v50, v50
    v_sin_f32 v59, v51
    v_cos_f32 v51, v51
    v_sin_f32 v60, v52
    v_cos_f32 v52, v52
    v_sin_f32 v61, v53
    v_cos_f32 v53, v53
    s_nop 0
    v_cvt_pk_bf16_f32 v68, v50, v58
    v_cvt_pk_bf16_f32 v72, -v58, v50
    v_cvt_pk_bf16_f32 v69, v51, v59
    v_cvt_pk_bf16_f32 v73, -v59, v51
    v_cvt_pk_bf16_f32 v70, v52, v60
    v_cvt_pk_bf16_f32 v74, -v60, v52
    v_cvt_pk_bf16_f32 v71, v53, v61
    v_cvt_pk_bf16_f32 v75, -v61, v53
    s_lshl_b32 s55, s36, 11
    v_add_u32 v66, s55, v2
    ds_write_b128 v66, v[68:71] offset:0
    ds_write_b128 v66, v[72:75] offset:1024
    s_branch K2_JD
K2_J3:
    v_bfe_u32 v48, v1, 2, 1
    v_lshlrev_b32 v48, 3, v48
    v_bfe_u32 v49, v1, 3, 1
    v_lshl_add_u32 v48, v49, 2, v48
    v_and_b32 v49, 19, v1
    v_add_u32 v48, v48, v49
    v_cvt_f32_u32 v48, v48
    v_mul_f32 v48, 0x3d000000, v48
    s_and_b32 s53, s36, 1
    s_lshl_b32 s55, s53, 10
    s_lshl_b32 s53, s53, 4
    v_cvt_f32_u32 v49, s53
    v_fma_f32 v49, v4, 4.0, v49
    v_add_u32 v66, s55, v2
    v_mul_f32 v49, v48, v49
    s_mov_b32 s54, 0x00000000
    v_fma_f32 v50, v48, s54, v49
    s_mov_b32 s54, 0x3f800000
    v_fma_f32 v51, v48, s54, v49
    s_mov_b32 s54, 0x40000000
    v_fma_f32 v52, v48, s54, v49
    s_mov_b32 s54, 0x40400000
    v_fma_f32 v53, v48, s54, v49
    s_mov_b32 s54, 0x41000000
    v_fma_f32 v54, v48, s54, v49
    s_mov_b32 s54, 0x41100000
    v_fma_f32 v55, v48, s54, v49
    s_mov_b32 s54, 0x41200000
    v_fma_f32 v56, v48, s54, v49
    s_mov_b32 s54, 0x41300000
    v_fma_f32 v57, v48, s54, v49
    v_sin_f32 v58, v50
    v_cos_f32 v50, v50
    v_sin_f32 v59, v51
    v_cos_f32 v51, v51
    v_sin_f32 v60, v52
    v_cos_f32 v52, v52
    v_sin_f32 v61, v53
    v_cos_f32 v53, v53
    v_sin_f32 v62, v54
    v_cos_f32 v54, v54
    v_sin_f32 v63, v55
    v_cos_f32 v55, v55
    v_sin_f32 v64, v56
    v_cos_f32 v56, v56
    v_sin_f32 v65, v57
    v_cos_f32 v57, v57
    s_nop 0
    v_cvt_pk_bf16_f32 v68, v50, v51
    v_cvt_pk_bf16_f32 v72, v58, v59
    v_cvt_pk_bf16_f32 v69, v52, v53
    v_cvt_pk_bf16_f32 v73, v60, v61
    v_cvt_pk_bf16_f32 v70, v54, v55
    v_cvt_pk_bf16_f32 v74, v62, v63
    v_cvt_pk_bf16_f32 v71, v56, v57
    v_cvt_pk_bf16_f32 v75, v64, v65
    v_xor_b32 v76, 0x80008000, v72
    v_xor_b32 v77, 0x80008000, v73
    v_xor_b32 v78, 0x80008000, v74
    v_xor_b32 v79, 0x80008000, v75
    ds_write_b128 v66, v[68:71] offset:32768
    ds_write_b128 v66, v[72:75] offset:34816
    ds_write_b128 v66, v[76:79] offset:36864
K2_JD:
    s_cmp_lg_u32 s36, 7
    s_cbranch_scc1 K2_FSP_OK
    s_mov_b32 s47, 65536
    s_waitcnt vmcnt(0)
    s_branch K2_FSP_C
    s_mov_b32 s47, 65536
K2_FSP:
    buffer_load_dwordx4 v[16:19], v2, s[24:27], s58 offen offset:0 sc1
    buffer_load_dwordx4 v[20:23], v2, s[24:27], s58 offen offset:1024 sc1
    buffer_load_dwordx4 v[24:27], v2, s[24:27], s58 offen offset:2048 sc1
    buffer_load_dwordx4 v[28:31], v2, s[24:27], s58 offen offset:3072 sc1
    buffer_load_dwordx4 v[32:35], v2, s[24:27], s59 offen offset:0 sc1
    buffer_load_dwordx4 v[36:39], v2, s[24:27], s59 offen offset:1024 sc1
    buffer_load_dwordx4 v[40:43], v2, s[24:27], s59 offen offset:2048 sc1
    buffer_load_dwordx4 v[44:47], v2, s[24:27], s59 offen offset:3072 sc1
    s_waitcnt vmcnt(0)
K2_FSP_C:
    v_xor_b32 v16, s62, v16
    v_xor_b32 v17, s62, v17
    v_or_b32 v16, v16, v17
    v_xor_b32 v18, s62, v18
    v_or_b32 v16, v16, v18
    v_xor_b32 v19, s62, v19
    v_or_b32 v16, v16, v19
    v_xor_b32 v20, s62, v20
    v_or_b32 v16, v16, v20
    v_xor_b32 v21, s62, v21
    v_or_b32 v16, v16, v21
    v_xor_b32 v22, s62, v22
    v_or_b32 v16, v16, v22
    v_xor_b32 v23, s62, v23
    v_or_b32 v16, v16, v23
    v_xor_b32 v24, s62, v24
    v_or_b32 v16, v16, v24
    v_xor_b32 v25, s62, v25
    v_or_b32 v16, v16, v25
    v_xor_b32 v26, s62, v26
    v_or_b32 v16, v16, v26
    v_xor_b32 v27, s62, v27
    v_or_b32 v16, v16, v27
    v_xor_b32 v28, s62, v28
    v_or_b32 v16, v16, v28
    v_xor_b32 v29, s62, v29
    v_or_b32 v16, v16, v29
    v_xor_b32 v30, s62, v30
    v_or_b32 v16, v16, v30
    v_xor_b32 v31, s62, v31
    v_or_b32 v16, v16, v31
    v_xor_b32 v32, s62, v32
    v_or_b32 v16, v16, v32
    v_xor_b32 v33, s62, v33
    v_or_b32 v16, v16, v33
    v_xor_b32 v34, s62, v34
    v_or_b32 v16, v16, v34
    v_xor_b32 v35, s62, v35
    v_or_b32 v16, v16, v35
    v_xor_b32 v36, s62, v36
    v_or_b32 v16, v16, v36
    v_xor_b32 v37, s62, v37
    v_or_b32 v16, v16, v37
    v_xor_b32 v38, s62, v38
    v_or_b32 v16, v16, v38
    v_xor_b32 v39, s62, v39
    v_or_b32 v16, v16, v39
    v_xor_b32 v40, s62, v40
    v_or_b32 v16, v16, v40
    v_xor_b32 v41, s62, v41
    v_or_b32 v16, v16, v41
    v_xor_b32 v42, s62, v42
    v_or_b32 v16, v16, v42
    v_xor_b32 v43, s62, v43
    v_or_b32 v16, v16, v43
    v_xor_b32 v44, s62, v44
    v_or_b32 v16, v16, v44
    v_xor_b32 v45, s62, v45
    v_or_b32 v16, v16, v45
    v_xor_b32 v46, s62, v46
    v_or_b32 v16, v16, v46
    v_xor_b32 v47, s62, v47
    v_or_b32 v16, v16, v47
    v_cmp_ne_u32 vcc, 0, v16
    s_cbranch_vccz K2_FSP_OK
    s_sleep 4
    s_sub_u32 s47, s47, 1
    s_cmp_lg_u32 s47, 0
    s_cbranch_scc1 K2_FSP
K2_FSP_OK:
    s_waitcnt lgkmcnt(0)
    s_barrier
    buffer_store_dwordx4 v[224:227], v2, s[24:27], s4 offen offset:1024 sc1
    buffer_store_dwordx4 v[228:231], v2, s[24:27], s5 offen offset:1024 sc1
    buffer_store_dwordx4 v[232:235], v2, s[24:27], s6 offen offset:1024 sc1
    buffer_store_dwordx4 v[236:239], v2, s[24:27], s7 offen offset:1024 sc1
    s_cmp_ge_u32 s36, 4
    s_cbranch_scc1 K2_FD
    buffer_store_dwordx2 v[240:241], v220, s[24:27], s8 offen sc1
    buffer_store_dwordx2 v[244:245], v220, s[24:27], s9 offen sc1
    buffer_store_dwordx2 v[248:249], v220, s[24:27], s10 offen sc1
    buffer_store_dwordx2 v[252:253], v220, s[24:27], s11 offen sc1
K2_FD:
    s_cmp_lt_u32 s36, 5
    s_cbranch_scc1 K2_FE
    s_mul_i32 s52, s37, 3
    s_add_u32 s52, s52, s36
    s_mul_i32 s52, s52, 3456
    s_add_u32 s52, s52, 36257152
    buffer_load_dwordx4 v[16:19], v2, s[24:27], s52 offen offset:0 sc1
    buffer_load_dwordx4 v[20:23], v2, s[24:27], s52 offen offset:1024 sc1
    buffer_load_dwordx4 v[24:27], v2, s[24:27], s52 offen offset:2048 sc1
    buffer_load_dwordx4 v[28:31], v2, s[24:27], s52 offen offset:2432 sc1
K2_FE:
    s_cmp_gt_u32 s38, 288
    s_cbranch_scc0 K2_FF
    s_waitcnt vmcnt(0)
    v_mov_b32 v14, s62
    v_mov_b32 v15, 0
    s_mov_b64 exec, 1
    buffer_store_dword v14, v15, s[24:27], s63 offen sc1
    s_mov_b64 exec, -1
    s_add_u32 s63, s63, 8192
    v_mov_b32 v48, s62
    v_mov_b32 v49, 0
    s_mov_b64 exec, 1
    buffer_store_dword v48, v49, s[24:27], s63 offen sc1
    s_mov_b64 exec, -1
    s_branch K2_FIN
K2_FF:
    s_cmp_lg_u32 s36, 4
    s_cbranch_scc1 K2_FP
    s_setprio 1
K2_FP:
    v_add_u32 v15, 45056, v2
    v_and_b32 v13, 31, v1
    v_lshlrev_b32 v13, 5, v13
    v_lshrrev_b32 v14, 5, v1
    v_lshl_add_u32 v13, v14, 4, v13
    v_lshlrev_b32 v14, 5, v14
    v_and_b32 v5, 31, v1
    v_lshl_add_u32 v14, v5, 7, v14
    s_mul_i32 s52, s38, 8448
    s_cmp_eq_u32 s38, 288
    s_cselect_b32 s52, 4224, s52
    s_add_u32 s52, s52, 23879936
    s_add_u32 s55, s52, 4224
    s_cmp_eq_u32 s39, 0
    s_cselect_b32 s55, s55, 0x40000000
    s_mov_b32 s53, 36937984
    s_mov_b32 s54, 36942080
    ds_read_b128 v[240:243], v2 offset:0
    ds_read_b128 v[244:247], v2 offset:2048
    ds_read_b128 v[248:251], v2 offset:4096
    s_waitcnt vmcnt(12)
    v_xor_b32 v5, 0, v12
    ds_read_b128 v[16:19], v5 offset:0
    ds_read_b128 v[32:35], v5 offset:4096
    v_xor_b32 v6, 32, v12
    ds_read_b128 v[20:23], v6 offset:0
    ds_read_b128 v[36:39], v6 offset:4096
    v_xor_b32 v5, 64, v12
    ds_read_b128 v[24:27], v5 offset:0
    ds_read_b128 v[40:43], v5 offset:4096
    v_xor_b32 v6, 96, v12
    ds_read_b128 v[28:31], v6 offset:0
    ds_read_b128 v[44:47], v6 offset:4096
    s_waitcnt lgkmcnt(0)
    s_cbranch_scc1 K2_NOSPEC
    s_cmp_eq_u32 s38, 0
    s_cselect_b32 s56, 0, 16
    v_bfe_u32 v16, v16, s56, 16
    v_bfe_u32 v17, v17, s56, 16
    v_bfe_u32 v18, v18, s56, 16
    v_bfe_u32 v19, v19, s56, 16
    v_bfe_u32 v20, v20, s56, 16
    v_bfe_u32 v21, v21, s56, 16
    v_bfe_u32 v22, v22, s56, 16
    v_bfe_u32 v23, v23, s56, 16
    v_bfe_u32 v24, v24, s56, 16
    v_bfe_u32 v25, v25, s56, 16
    v_bfe_u32 v26, v26, s56, 16
    v_bfe_u32 v27, v27, s56, 16
    v_bfe_u32 v28, v28, s56, 16
    v_bfe_u32 v29, v29, s56, 16
    v_bfe_u32 v30, v30, s56, 16
    v_bfe_u32 v31, v31, s56, 16
    v_bfe_u32 v32, v32, s56, 16
    v_bfe_u32 v33, v33, s56, 16
    v_bfe_u32 v34, v34, s56, 16
    v_bfe_u32 v35, v35, s56, 16
    v_bfe_u32 v36, v36, s56, 16
    v_bfe_u32 v37, v37, s56, 16
    v_bfe_u32 v38, v38, s56, 16
    v_bfe_u32 v39, v39, s56, 16
    v_bfe_u32 v40, v40, s56, 16
    v_bfe_u32 v41, v41, s56, 16
    v_bfe_u32 v42, v42, s56, 16
    v_bfe_u32 v43, v43, s56, 16
    v_bfe_u32 v44, v44, s56, 16
    v_bfe_u32 v45, v45, s56, 16
    v_bfe_u32 v46, v46, s56, 16
    v_bfe_u32 v47, v47, s56, 16
    s_nop 1
K2_NOSPEC:
    s_waitcnt lgkmcnt(2)
    v_mfma_f32_32x32x16_bf16 v[48:63], v[16:19], v[240:243], 0
    ds_read_b128 v[252:255], v2 offset:6144
    s_waitcnt lgkmcnt(2)
    v_mfma_f32_32x32x16_bf16 v[48:63], v[20:23], v[244:247], v[48:63]
    ds_read_b128 v[240:243], v2 offset:1024
    s_waitcnt lgkmcnt(2)
    v_mfma_f32_32x32x16_bf16 v[48:63], v[24:27], v[248:251], v[48:63]
    ds_read_b128 v[244:247], v2 offset:3072
    s_waitcnt lgkmcnt(2)
    v_mfma_f32_32x32x16_bf16 v[48:63], v[28:31], v[252:255], v[48:63]
    ds_read_b128 v[248:251], v2 offset:5120
    s_waitcnt lgkmcnt(2)
    v_mfma_f32_32x32x16_bf16 v[80:95], v[16:19], v[240:243], 0
    ds_read_b128 v[252:255], v2 offset:7168
    s_waitcnt lgkmcnt(2)
    v_mfma_f32_32x32x16_bf16 v[80:95], v[20:23], v[244:247], v[80:95]
    ds_read_b128 v[240:243], v2 offset:0
    s_waitcnt lgkmcnt(2)
    v_mfma_f32_32x32x16_bf16 v[80:95], v[24:27], v[248:251], v[80:95]
    ds_read_b128 v[244:247], v2 offset:2048
    s_waitcnt lgkmcnt(2)
    v_mfma_f32_32x32x16_bf16 v[80:95], v[28:31], v[252:255], v[80:95]
    ds_read_b128 v[248:251], v2 offset:4096
    s_waitcnt lgkmcnt(2)
    v_mfma_f32_32x32x16_bf16 v[64:79], v[32:35], v[240:243], 0
    ds_read_b128 v[252:255], v2 offset:6144
    s_waitcnt lgkmcnt(2)
    v_mfma_f32_32x32x16_bf16 v[64:79], v[36:39], v[244:247], v[64:79]
    ds_read_b128 v[240:243], v2 offset:1024
    s_nop 7
    s_waitcnt lgkmcnt(2)
    v_mfma_f32_32x32x16_bf16 v[64:79], v[40:43], v[248:251], v[64:79]
    ds_read_b128 v[244:247], v2 offset:3072
    ds_read_b128 v[16:19], v15 offset:0
    ds_read_b128 v[20:23], v15 offset:1024
    ds_read_b128 v[24:27], v15 offset:2048
    s_waitcnt lgkmcnt(2)
    v_mul_f32 v5, v48, v16
    v_mul_f32 v6, v80, v16
    v_fma_f32 v5, v80, v17, v5
    v_fma_f32 v6, -v48, v17, v6
    v_mul_f32 v7, v49, v18
    v_mul_f32 v8, v81, v18
    v_fma_f32 v7, v81, v19, v7
    v_fma_f32 v8, -v49, v19, v8
    ds_read_b128 v[28:31], v15 offset:3072
    v_cvt_pk_bf16_f32 v208, v5, v7
    v_cvt_pk_bf16_f32 v224, v6, v8
    s_waitcnt lgkmcnt(2)
    v_mfma_f32_32x32x16_bf16 v[64:79], v[44:47], v[252:255], v[64:79]
    ds_read_b128 v[248:251], v2 offset:5120
    v_mul_f32 v5, v50, v20
    v_mul_f32 v6, v82, v20
    v_fma_f32 v5, v82, v21, v5
    v_fma_f32 v6, -v50, v21, v6
    v_mul_f32 v7, v51, v22
    v_mul_f32 v8, v83, v22
    v_fma_f32 v7, v83, v23, v7
    v_fma_f32 v8, -v51, v23, v8
    ds_read_b128 v[16:19], v15 offset:4096
    v_cvt_pk_bf16_f32 v209, v5, v7
    v_cvt_pk_bf16_f32 v225, v6, v8
    s_waitcnt lgkmcnt(3)
    v_mul_f32 v5, v52, v24
    v_mul_f32 v6, v84, v24
    v_fma_f32 v5, v84, v25, v5
    v_fma_f32 v6, -v52, v25, v6
    v_mfma_f32_32x32x16_bf16 v[96:111], v[32:35], v[240:243], 0
    ds_read_b128 v[252:255], v2 offset:7168
    v_mul_f32 v7, v53, v26
    v_mul_f32 v8, v85, v26
    v_fma_f32 v7, v85, v27, v7
    v_fma_f32 v8, -v53, v27, v8
    ds_read_b128 v[20:23], v15 offset:5120
    v_cvt_pk_bf16_f32 v210, v5, v7
    v_cvt_pk_bf16_f32 v226, v6, v8
    s_waitcnt lgkmcnt(4)
    v_mul_f32 v5, v54, v28
    v_mul_f32 v6, v86, v28
    v_fma_f32 v5, v86, v29, v5
    v_fma_f32 v6, -v54, v29, v6
    v_mul_f32 v7, v55, v30
    v_mul_f32 v8, v87, v30
    v_fma_f32 v7, v87, v31, v7
    v_fma_f32 v8, -v55, v31, v8
    v_mfma_f32_32x32x16_bf16 v[96:111], v[36:39], v[244:247], v[96:111]
    ds_read_b128 v[240:243], v2 offset:8192
    ds_read_b128 v[24:27], v15 offset:6144
    v_cvt_pk_bf16_f32 v211, v5, v7
    v_cvt_pk_bf16_f32 v227, v6, v8
    s_waitcnt lgkmcnt(4)
    v_mul_f32 v5, v56, v16
    v_mul_f32 v6, v88, v16
    v_fma_f32 v5, v88, v17, v5
    v_fma_f32 v6, -v56, v17, v6
    v_mul_f32 v7, v57, v18
    v_mul_f32 v8, v89, v18
    v_fma_f32 v7, v89, v19, v7
    v_fma_f32 v8, -v57, v19, v8
    ds_read_b128 v[28:31], v15 offset:7168
    v_cvt_pk_bf16_f32 v212, v5, v7
    v_cvt_pk_bf16_f32 v228, v6, v8
    s_waitcnt lgkmcnt(3)
    v_mfma_f32_32x32x16_bf16 v[96:111], v[40:43], v[248:251], v[96:111]
    ds_read_b128 v[244:247], v2 offset:9216
    v_mul_f32 v5, v58, v20
    v_mul_f32 v6, v90, v20
    v_fma_f32 v5, v90, v21, v5
    v_fma_f32 v6, -v58, v21, v6
    v_mul_f32 v7, v59, v22
    v_mul_f32 v8, v91, v22
    v_fma_f32 v7, v91, v23, v7
    v_fma_f32 v8, -v59, v23, v8
    v_cvt_pk_bf16_f32 v213, v5, v7
    v_cvt_pk_bf16_f32 v229, v6, v8
    s_waitcnt lgkmcnt(2)
    v_mul_f32 v5, v60, v24
    v_mul_f32 v6, v92, v24
    v_fma_f32 v5, v92, v25, v5
    v_fma_f32 v6, -v60, v25, v6
    v_mul_f32 v7, v61, v26
    v_mfma_f32_32x32x16_bf16 v[96:111], v[44:47], v[252:255], v[96:111]
    ds_read_b128 v[248:251], v2 offset:16384
    v_mul_f32 v8, v93, v26
    v_fma_f32 v7, v93, v27, v7
    v_fma_f32 v8, -v61, v27, v8
    v_cvt_pk_bf16_f32 v214, v5, v7
    v_cvt_pk_bf16_f32 v230, v6, v8
    s_waitcnt lgkmcnt(2)
    v_mul_f32 v5, v62, v28
    v_mul_f32 v6, v94, v28
    v_fma_f32 v5, v94, v29, v5
    v_fma_f32 v6, -v62, v29, v6
    v_mul_f32 v7, v63, v30
    v_mul_f32 v8, v95, v30
    v_fma_f32 v7, v95, v31, v7
    v_fma_f32 v8, -v63, v31, v8
    v_cvt_pk_bf16_f32 v215, v5, v7
    v_cvt_pk_bf16_f32 v231, v6, v8
    s_nop 1
    v_mfma_f32_32x32x16_bf16 v[112:127], v[240:243], v[208:211], 0
    ds_read_b128 v[252:255], v2 offset:17408
    s_waitcnt lgkmcnt(2)
    v_mfma_f32_32x32x16_bf16 v[112:127], v[244:247], v[212:215], v[112:127]
    ds_read_b128 v[240:243], v2 offset:24576
    s_nop 7
    s_waitcnt lgkmcnt(2)
    v_mfma_f32_32x32x16_bf16 v[112:127], v[248:251], v[224:227], v[112:127]
    ds_read_b128 v[244:247], v2 offset:25600
    ds_read_b128 v[16:19], v15 offset:8192
    ds_read_b128 v[20:23], v15 offset:9216
    ds_read_b128 v[24:27], v15 offset:10240
    s_waitcnt lgkmcnt(2)
    v_mul_f32 v5, v64, v16
    v_mul_f32 v6, v96, v16
    v_fma_f32 v5, v96, v17, v5
    v_mfma_f32_32x32x16_bf16 v[112:127], v[252:255], v[228:231], v[112:127]
    ds_read_b128 v[248:251], v2 offset:8192
    v_fma_f32 v6, -v64, v17, v6
    v_mul_f32 v7, v65, v18
    v_mul_f32 v8, v97, v18
    v_fma_f32 v7, v97, v19, v7
    v_fma_f32 v8, -v65, v19, v8
    ds_read_b128 v[28:31], v15 offset:11264
    v_cvt_pk_bf16_f32 v216, v5, v7
    v_mfma_f32_32x32x16_bf16 v[144:159], v[240:243], v[208:211], 0
    ds_read_b128 v[252:255], v2 offset:9216
    v_cvt_pk_bf16_f32 v232, v6, v8
    s_waitcnt lgkmcnt(4)
    v_mul_f32 v5, v66, v20
    v_mul_f32 v6, v98, v20
    v_fma_f32 v5, v98, v21, v5
    v_fma_f32 v6, -v66, v21, v6
    v_mul_f32 v7, v67, v22
    v_mfma_f32_32x32x16_bf16 v[144:159], v[244:247], v[212:215], v[144:159]
    ds_read_b128 v[240:243], v2 offset:12288
    v_mul_f32 v8, v99, v22
    v_fma_f32 v7, v99, v23, v7
    v_fma_f32 v8, -v67, v23, v8
    ds_read_b128 v[16:19], v15 offset:12288
    v_cvt_pk_bf16_f32 v217, v5, v7
    v_cvt_pk_bf16_f32 v233, v6, v8
    s_waitcnt lgkmcnt(5)
    s_waitcnt lgkmcnt(4)
    v_mfma_f32_32x32x16_bf16 v[144:159], v[248:251], v[224:227], v[144:159]
    ds_read_b128 v[244:247], v2 offset:13312
    v_mul_f32 v5, v68, v24
    v_mul_f32 v6, v100, v24
    v_fma_f32 v5, v100, v25, v5
    v_fma_f32 v6, -v68, v25, v6
    v_mul_f32 v7, v69, v26
    v_mul_f32 v8, v101, v26
    v_fma_f32 v7, v101, v27, v7
    s_waitcnt lgkmcnt(3)
    v_mfma_f32_32x32x16_bf16 v[144:159], v[252:255], v[228:231], v[144:159]
    ds_read_b128 v[248:251], v2 offset:20480
    v_fma_f32 v8, -v69, v27, v8
    ds_read_b128 v[20:23], v15 offset:13312
    v_cvt_pk_bf16_f32 v218, v5, v7
    v_cvt_pk_bf16_f32 v234, v6, v8
    v_mul_f32 v5, v70, v28
    v_mul_f32 v6, v102, v28
    s_waitcnt lgkmcnt(4)
    v_mfma_f32_32x32x16_bf16 v[128:143], v[240:243], v[208:211], 0
    ds_read_b128 v[252:255], v2 offset:21504
    v_fma_f32 v5, v102, v29, v5
    v_fma_f32 v6, -v70, v29, v6
    v_mul_f32 v7, v71, v30
    v_mul_f32 v8, v103, v30
    v_fma_f32 v7, v103, v31, v7
    v_fma_f32 v8, -v71, v31, v8
    s_waitcnt lgkmcnt(3)
    v_mfma_f32_32x32x16_bf16 v[128:143], v[244:247], v[212:215], v[128:143]
    ds_read_b128 v[240:243], v2 offset:28672
    ds_read_b128 v[24:27], v15 offset:14336
    v_cvt_pk_bf16_f32 v219, v5, v7
    v_cvt_pk_bf16_f32 v235, v6, v8
    v_mul_f32 v5, v72, v16
    v_mul_f32 v6, v104, v16
    v_fma_f32 v5, v104, v17, v5
    s_waitcnt lgkmcnt(4)
    v_mfma_f32_32x32x16_bf16 v[128:143], v[248:251], v[224:227], v[128:143]
    ds_read_b128 v[244:247], v2 offset:29696
    v_fma_f32 v6, -v72, v17, v6
    v_mul_f32 v7, v73, v18
    v_mul_f32 v8, v105, v18
    v_fma_f32 v7, v105, v19, v7
    v_fma_f32 v8, -v73, v19, v8
    ds_read_b128 v[28:31], v15 offset:15360
    v_cvt_pk_bf16_f32 v220, v5, v7
    s_waitcnt lgkmcnt(4)
    v_mfma_f32_32x32x16_bf16 v[128:143], v[252:255], v[228:231], v[128:143]
    ds_read_b128 v[248:251], v2 offset:12288
    v_cvt_pk_bf16_f32 v236, v6, v8
    v_mul_f32 v5, v74, v20
    v_mul_f32 v6, v106, v20
    v_fma_f32 v5, v106, v21, v5
    v_fma_f32 v6, -v74, v21, v6
    v_mul_f32 v7, v75, v22
    s_waitcnt lgkmcnt(4)
    v_mfma_f32_32x32x16_bf16 v[160:175], v[240:243], v[208:211], 0
    ds_read_b128 v[252:255], v2 offset:13312
    v_mul_f32 v8, v107, v22
    v_fma_f32 v7, v107, v23, v7
    v_fma_f32 v8, -v75, v23, v8
    v_cvt_pk_bf16_f32 v221, v5, v7
    v_cvt_pk_bf16_f32 v237, v6, v8
    s_waitcnt lgkmcnt(4)
    v_mul_f32 v5, v76, v24
    s_waitcnt lgkmcnt(3)
    v_mfma_f32_32x32x16_bf16 v[160:175], v[244:247], v[212:215], v[160:175]
    ds_read_b128 v[240:243], v2 offset:10240
    v_mul_f32 v6, v108, v24
    v_fma_f32 v5, v108, v25, v5
    v_fma_f32 v6, -v76, v25, v6
    v_mul_f32 v7, v77, v26
    v_mul_f32 v8, v109, v26
    v_fma_f32 v7, v109, v27, v7
    v_fma_f32 v8, -v77, v27, v8
    s_waitcnt lgkmcnt(2)
    v_mfma_f32_32x32x16_bf16 v[160:175], v[248:251], v[224:227], v[160:175]
    ds_read_b128 v[244:247], v2 offset:11264
    v_cvt_pk_bf16_f32 v222, v5, v7
    v_cvt_pk_bf16_f32 v238, v6, v8
    v_mul_f32 v5, v78, v28
    v_mul_f32 v6, v110, v28
    v_fma_f32 v5, v110, v29, v5
    v_fma_f32 v6, -v78, v29, v6
    s_waitcnt lgkmcnt(2)
    v_mfma_f32_32x32x16_bf16 v[160:175], v[252:255], v[228:231], v[160:175]
    ds_read_b128 v[248:251], v2 offset:18432
    v_mul_f32 v7, v79, v30
    v_mul_f32 v8, v111, v30
    v_fma_f32 v7, v111, v31, v7
    v_fma_f32 v8, -v79, v31, v8
    v_cvt_pk_bf16_f32 v223, v5, v7
    v_cvt_pk_bf16_f32 v239, v6, v8
    s_nop 1
    s_waitcnt lgkmcnt(2)
    v_mfma_f32_32x32x16_bf16 v[112:127], v[240:243], v[216:219], v[112:127]
    ds_read_b128 v[252:255], v2 offset:19456
    s_waitcnt lgkmcnt(2)
    v_mfma_f32_32x32x16_bf16 v[112:127], v[244:247], v[220:223], v[112:127]
    ds_read_b128 v[240:243], v2 offset:26624
    s_waitcnt lgkmcnt(2)
    v_mfma_f32_32x32x16_bf16 v[112:127], v[248:251], v[232:235], v[112:127]
    ds_read_b128 v[244:247], v2 offset:27648
    s_waitcnt lgkmcnt(2)
    v_mfma_f32_32x32x16_bf16 v[112:127], v[252:255], v[236:239], v[112:127]
    ds_read_b128 v[248:251], v2 offset:10240
    s_waitcnt lgkmcnt(2)
    v_mfma_f32_32x32x16_bf16 v[144:159], v[240:243], v[216:219], v[144:159]
    ds_read_b128 v[252:255], v2 offset:11264
    s_waitcnt lgkmcnt(2)
    v_mfma_f32_32x32x16_bf16 v[144:159], v[244:247], v[220:223], v[144:159]
    ds_read_b128 v[240:243], v2 offset:14336
    s_waitcnt lgkmcnt(2)
    v_mfma_f32_32x32x16_bf16 v[144:159], v[248:251], v[232:235], v[144:159]
    ds_read_b128 v[244:247], v2 offset:15360
    s_waitcnt lgkmcnt(2)
    v_mfma_f32_32x32x16_bf16 v[144:159], v[252:255], v[236:239], v[144:159]
    ds_read_b128 v[248:251], v2 offset:22528
    s_cmp_lt_u32 s36, 4
    s_cbranch_scc1 K2_FW
    s_waitcnt vmcnt(4)
K2_FW:
    s_waitcnt vmcnt(8)
    s_waitcnt lgkmcnt(2)
    v_mfma_f32_32x32x16_bf16 v[128:143], v[240:243], v[216:219], v[128:143]
    ds_read_b128 v[252:255], v2 offset:23552
    s_waitcnt lgkmcnt(2)
    v_mfma_f32_32x32x16_bf16 v[128:143], v[244:247], v[220:223], v[128:143]
    ds_read_b128 v[240:243], v2 offset:30720
    s_nop 7
    s_waitcnt lgkmcnt(2)
    v_mfma_f32_32x32x16_bf16 v[128:143], v[248:251], v[232:235], v[128:143]
    ds_read_b128 v[244:247], v2 offset:31744
    v_lshlrev_b32 v9, 16, v176
    v_and_b32 v10, 0xffff0000, v176
    v_mul_f32 v5, v112, v9
    v_mul_f32 v6, v144, v9
    v_fma_f32 v5, -v144, v10, v5
    v_fma_f32 v6, v112, v10, v6
    v_lshlrev_b32 v11, 16, v177
    v_and_b32 v12, 0xffff0000, v177
    v_mul_f32 v7, v113, v11
    v_mul_f32 v8, v145, v11
    v_fma_f32 v7, -v145, v12, v7
    v_fma_f32 v8, v113, v12, v8
    v_cvt_pk_bf16_f32 v208, v5, v7
    v_cvt_pk_bf16_f32 v224, v6, v8
    v_lshlrev_b32 v9, 16, v178
    v_and_b32 v10, 0xffff0000, v178
    v_mul_f32 v5, v114, v9
    v_mul_f32 v6, v146, v9
    v_fma_f32 v5, -v146, v10, v5
    s_waitcnt lgkmcnt(2)
    v_mfma_f32_32x32x16_bf16 v[128:143], v[252:255], v[236:239], v[128:143]
    ds_read_b128 v[248:251], v2 offset:14336
    v_fma_f32 v6, v114, v10, v6
    v_lshlrev_b32 v11, 16, v179
    v_and_b32 v12, 0xffff0000, v179
    v_mul_f32 v7, v115, v11
    v_mul_f32 v8, v147, v11
    v_fma_f32 v7, -v147, v12, v7
    v_fma_f32 v8, v115, v12, v8
    v_cvt_pk_bf16_f32 v209, v5, v7
    v_cvt_pk_bf16_f32 v225, v6, v8
    v_lshlrev_b32 v9, 16, v180
    v_and_b32 v10, 0xffff0000, v180
    v_mul_f32 v5, v116, v9
    v_mul_f32 v6, v148, v9
    v_fma_f32 v5, -v148, v10, v5
    v_fma_f32 v6, v116, v10, v6
    v_lshlrev_b32 v11, 16, v181
    v_and_b32 v12, 0xffff0000, v181
    v_mul_f32 v7, v117, v11
    v_mul_f32 v8, v149, v11
    s_waitcnt lgkmcnt(2)
    v_mfma_f32_32x32x16_bf16 v[160:175], v[240:243], v[216:219], v[160:175]
    ds_read_b128 v[252:255], v2 offset:15360
    v_fma_f32 v7, -v149, v12, v7
    v_fma_f32 v8, v117, v12, v8
    v_cvt_pk_bf16_f32 v210, v5, v7
    v_cvt_pk_bf16_f32 v226, v6, v8
    v_lshlrev_b32 v9, 16, v182
    v_and_b32 v10, 0xffff0000, v182
    v_mul_f32 v5, v118, v9
    v_mul_f32 v6, v150, v9
    v_fma_f32 v5, -v150, v10, v5
    v_fma_f32 v6, v118, v10, v6
    v_lshlrev_b32 v11, 16, v183
    v_and_b32 v12, 0xffff0000, v183
    v_mul_f32 v7, v119, v11
    v_mul_f32 v8, v151, v11
    v_fma_f32 v7, -v151, v12, v7
    v_fma_f32 v8, v119, v12, v8
    v_cvt_pk_bf16_f32 v211, v5, v7
    v_cvt_pk_bf16_f32 v227, v6, v8
    s_waitcnt lgkmcnt(2)
    v_mfma_f32_32x32x16_bf16 v[160:175], v[244:247], v[220:223], v[160:175]
    ds_read_b128 v[240:243], v2 offset:8192
    v_lshlrev_b32 v9, 16, v184
    v_and_b32 v10, 0xffff0000, v184
    v_mul_f32 v5, v120, v9
    v_mul_f32 v6, v152, v9
    v_fma_f32 v5, -v152, v10, v5
    v_fma_f32 v6, v120, v10, v6
    v_lshlrev_b32 v11, 16, v185
    v_and_b32 v12, 0xffff0000, v185
    v_mul_f32 v7, v121, v11
    v_mul_f32 v8, v153, v11
    v_fma_f32 v7, -v153, v12, v7
    v_fma_f32 v8, v121, v12, v8
    v_cvt_pk_bf16_f32 v212, v5, v7
    v_cvt_pk_bf16_f32 v228, v6, v8
    v_lshlrev_b32 v9, 16, v186
    v_and_b32 v10, 0xffff0000, v186
    v_mul_f32 v5, v122, v9
    v_mul_f32 v6, v154, v9
    v_fma_f32 v5, -v154, v10, v5
    s_waitcnt lgkmcnt(2)
    v_mfma_f32_32x32x16_bf16 v[160:175], v[248:251], v[232:235], v[160:175]
    ds_read_b128 v[244:247], v2 offset:9216
    v_fma_f32 v6, v122, v10, v6
    v_lshlrev_b32 v11, 16, v187
    v_and_b32 v12, 0xffff0000, v187
    v_mul_f32 v7, v123, v11
    v_mul_f32 v8, v155, v11
    v_fma_f32 v7, -v155, v12, v7
    v_fma_f32 v8, v123, v12, v8
    v_cvt_pk_bf16_f32 v213, v5, v7
    v_cvt_pk_bf16_f32 v229, v6, v8
    v_lshlrev_b32 v9, 16, v188
    v_and_b32 v10, 0xffff0000, v188
    v_mul_f32 v5, v124, v9
    v_mul_f32 v6, v156, v9
    v_fma_f32 v5, -v156, v10, v5
    v_fma_f32 v6, v124, v10, v6
    v_lshlrev_b32 v11, 16, v189
    v_and_b32 v12, 0xffff0000, v189
    v_mul_f32 v7, v125, v11
    v_mul_f32 v8, v157, v11
    s_waitcnt lgkmcnt(2)
    v_mfma_f32_32x32x16_bf16 v[160:175], v[252:255], v[236:239], v[160:175]
    ds_read_b128 v[248:251], v2 offset:24576
    v_fma_f32 v7, -v157, v12, v7
    v_fma_f32 v8, v125, v12, v8
    v_cvt_pk_bf16_f32 v214, v5, v7
    v_cvt_pk_bf16_f32 v230, v6, v8
    v_lshlrev_b32 v9, 16, v190
    v_and_b32 v10, 0xffff0000, v190
    v_mul_f32 v5, v126, v9
    v_mul_f32 v6, v158, v9
    v_fma_f32 v5, -v158, v10, v5
    v_fma_f32 v6, v126, v10, v6
    v_lshlrev_b32 v11, 16, v191
    v_and_b32 v12, 0xffff0000, v191
    v_mul_f32 v7, v127, v11
    v_mul_f32 v8, v159, v11
    v_fma_f32 v7, -v159, v12, v7
    v_fma_f32 v8, v127, v12, v8
    v_cvt_pk_bf16_f32 v215, v5, v7
    v_cvt_pk_bf16_f32 v231, v6, v8
    s_nop 1
    s_waitcnt lgkmcnt(2)
    v_mfma_f32_32x32x16_bf16 v[48:63], v[208:211], v[240:243], 0
    ds_read_b128 v[252:255], v2 offset:25600
    s_waitcnt lgkmcnt(2)
    v_mfma_f32_32x32x16_bf16 v[48:63], v[212:215], v[244:247], v[48:63]
    ds_read_b128 v[240:243], v2 offset:16384
    s_nop 7
    s_waitcnt lgkmcnt(2)
    v_mfma_f32_32x32x16_bf16 v[48:63], v[224:227], v[248:251], v[48:63]
    ds_read_b128 v[244:247], v2 offset:17408
    v_lshlrev_b32 v9, 16, v192
    v_and_b32 v10, 0xffff0000, v192
    v_mul_f32 v5, v128, v9
    v_mul_f32 v6, v160, v9
    v_fma_f32 v5, -v160, v10, v5
    v_fma_f32 v6, v128, v10, v6
    v_lshlrev_b32 v11, 16, v193
    v_and_b32 v12, 0xffff0000, v193
    s_waitcnt lgkmcnt(2)
    v_mfma_f32_32x32x16_bf16 v[48:63], v[228:231], v[252:255], v[48:63]
    ds_read_b128 v[248:251], v2 offset:8192
    v_mul_f32 v7, v129, v11
    v_mul_f32 v8, v161, v11
    v_fma_f32 v7, -v161, v12, v7
    v_fma_f32 v8, v129, v12, v8
    v_cvt_pk_bf16_f32 v216, v5, v7
    v_cvt_pk_bf16_f32 v232, v6, v8
    v_lshlrev_b32 v9, 16, v194
    v_and_b32 v10, 0xffff0000, v194
    s_waitcnt lgkmcnt(2)
    v_mfma_f32_32x32x16_bf16 v[80:95], v[208:211], v[240:243], 0
    ds_read_b128 v[252:255], v2 offset:9216
    v_mul_f32 v5, v130, v9
    v_mul_f32 v6, v162, v9
    v_fma_f32 v5, -v162, v10, v5
    v_fma_f32 v6, v130, v10, v6
    v_lshlrev_b32 v11, 16, v195
    v_and_b32 v12, 0xffff0000, v195
    v_mul_f32 v7, v131, v11
    v_mul_f32 v8, v163, v11
    s_waitcnt lgkmcnt(2)
    v_mfma_f32_32x32x16_bf16 v[80:95], v[212:215], v[244:247], v[80:95]
    ds_read_b128 v[240:243], v2 offset:12288
    v_fma_f32 v7, -v163, v12, v7
    v_fma_f32 v8, v131, v12, v8
    v_cvt_pk_bf16_f32 v217, v5, v7
    v_cvt_pk_bf16_f32 v233, v6, v8
    v_lshlrev_b32 v9, 16, v196
    v_and_b32 v10, 0xffff0000, v196
    v_mul_f32 v5, v132, v9
    v_mul_f32 v6, v164, v9
    s_waitcnt lgkmcnt(2)
    v_mfma_f32_32x32x16_bf16 v[80:95], v[224:227], v[248:251], v[80:95]
    ds_read_b128 v[244:247], v2 offset:13312
    v_fma_f32 v5, -v164, v10, v5
    v_fma_f32 v6, v132, v10, v6
    v_lshlrev_b32 v11, 16, v197
    v_and_b32 v12, 0xffff0000, v197
    v_mul_f32 v7, v133, v11
    v_mul_f32 v8, v165, v11
    v_fma_f32 v7, -v165, v12, v7
    v_fma_f32 v8, v133, v12, v8
    s_waitcnt lgkmcnt(2)
    v_mfma_f32_32x32x16_bf16 v[80:95], v[228:231], v[252:255], v[80:95]
    ds_read_b128 v[248:251], v2 offset:28672
    v_cvt_pk_bf16_f32 v218, v5, v7
    v_cvt_pk_bf16_f32 v234, v6, v8
    v_lshlrev_b32 v9, 16, v198
    v_and_b32 v10, 0xffff0000, v198
    v_mul_f32 v5, v134, v9
    v_mul_f32 v6, v166, v9
    v_fma_f32 v5, -v166, v10, v5
    v_fma_f32 v6, v134, v10, v6
    s_waitcnt lgkmcnt(2)
    v_mfma_f32_32x32x16_bf16 v[64:79], v[208:211], v[240:243], 0
    ds_read_b128 v[252:255], v2 offset:29696
    v_lshlrev_b32 v11, 16, v199
    v_and_b32 v12, 0xffff0000, v199
    v_mul_f32 v7, v135, v11
    v_mul_f32 v8, v167, v11
    v_fma_f32 v7, -v167, v12, v7
    v_fma_f32 v8, v135, v12, v8
    v_cvt_pk_bf16_f32 v219, v5, v7
    v_cvt_pk_bf16_f32 v235, v6, v8
    s_waitcnt lgkmcnt(2)
    v_mfma_f32_32x32x16_bf16 v[64:79], v[212:215], v[244:247], v[64:79]
    ds_read_b128 v[240:243], v2 offset:20480
    v_lshlrev_b32 v9, 16, v200
    v_and_b32 v10, 0xffff0000, v200
    v_mul_f32 v5, v136, v9
    v_mul_f32 v6, v168, v9
    v_fma_f32 v5, -v168, v10, v5
    v_fma_f32 v6, v136, v10, v6
    v_lshlrev_b32 v11, 16, v201
    v_and_b32 v12, 0xffff0000, v201
    s_waitcnt lgkmcnt(2)
    v_mfma_f32_32x32x16_bf16 v[64:79], v[224:227], v[248:251], v[64:79]
    ds_read_b128 v[244:247], v2 offset:21504
    v_mul_f32 v7, v137, v11
    v_mul_f32 v8, v169, v11
    v_fma_f32 v7, -v169, v12, v7
    v_fma_f32 v8, v137, v12, v8
    v_cvt_pk_bf16_f32 v220, v5, v7
    v_cvt_pk_bf16_f32 v236, v6, v8
    v_lshlrev_b32 v9, 16, v202
    v_and_b32 v10, 0xffff0000, v202
    s_waitcnt lgkmcnt(2)
    v_mfma_f32_32x32x16_bf16 v[64:79], v[228:231], v[252:255], v[64:79]
    ds_read_b128 v[248:251], v2 offset:12288
    v_mul_f32 v5, v138, v9
    v_mul_f32 v6, v170, v9
    v_fma_f32 v5, -v170, v10, v5
    v_fma_f32 v6, v138, v10, v6
    v_lshlrev_b32 v11, 16, v203
    v_and_b32 v12, 0xffff0000, v203
    v_mul_f32 v7, v139, v11
    v_mul_f32 v8, v171, v11
    s_waitcnt lgkmcnt(2)
    v_mfma_f32_32x32x16_bf16 v[96:111], v[208:211], v[240:243], 0
    ds_read_b128 v[252:255], v2 offset:13312
    v_fma_f32 v7, -v171, v12, v7
    v_fma_f32 v8, v139, v12, v8
    v_cvt_pk_bf16_f32 v221, v5, v7
    v_cvt_pk_bf16_f32 v237, v6, v8
    v_lshlrev_b32 v9, 16, v204
    v_and_b32 v10, 0xffff0000, v204
    v_mul_f32 v5, v140, v9
    v_mul_f32 v6, v172, v9
    s_waitcnt lgkmcnt(2)
    v_mfma_f32_32x32x16_bf16 v[96:111], v[212:215], v[244:247], v[96:111]
    ds_read_b128 v[240:243], v2 offset:10240
    v_fma_f32 v5, -v172, v10, v5
    v_fma_f32 v6, v140, v10, v6
    v_lshlrev_b32 v11, 16, v205
    v_and_b32 v12, 0xffff0000, v205
    v_mul_f32 v7, v141, v11
    v_mul_f32 v8, v173, v11
    v_fma_f32 v7, -v173, v12, v7
    v_fma_f32 v8, v141, v12, v8
    s_waitcnt lgkmcnt(2)
    v_mfma_f32_32x32x16_bf16 v[96:111], v[224:227], v[248:251], v[96:111]
    ds_read_b128 v[244:247], v2 offset:11264
    v_cvt_pk_bf16_f32 v222, v5, v7
    v_cvt_pk_bf16_f32 v238, v6, v8
    v_lshlrev_b32 v9, 16, v206
    v_and_b32 v10, 0xffff0000, v206
    v_mul_f32 v5, v142, v9
    v_mul_f32 v6, v174, v9
    v_fma_f32 v5, -v174, v10, v5
    v_fma_f32 v6, v142, v10, v6
    s_waitcnt lgkmcnt(2)
    v_mfma_f32_32x32x16_bf16 v[96:111], v[228:231], v[252:255], v[96:111]
    ds_read_b128 v[248:251], v2 offset:26624
    v_lshlrev_b32 v11, 16, v207
    v_and_b32 v12, 0xffff0000, v207
    v_mul_f32 v7, v143, v11
    v_mul_f32 v8, v175, v11
    v_fma_f32 v7, -v175, v12, v7
    v_fma_f32 v8, v143, v12, v8
    v_cvt_pk_bf16_f32 v223, v5, v7
    v_cvt_pk_bf16_f32 v239, v6, v8
    s_nop 1
    buffer_load_dwordx4 v[176:179], v14, s[24:27], s53 offen offset:0 sc1
    buffer_load_dwordx4 v[180:183], v14, s[24:27], s53 offen offset:16 sc1
    buffer_load_dwordx4 v[184:187], v14, s[24:27], s53 offen offset:64 sc1
    buffer_load_dwordx4 v[188:191], v14, s[24:27], s53 offen offset:80 sc1
    buffer_load_dwordx4 v[192:195], v14, s[24:27], s54 offen offset:0 sc1
    buffer_load_dwordx4 v[196:199], v14, s[24:27], s54 offen offset:16 sc1
    buffer_load_dwordx4 v[200:203], v14, s[24:27], s54 offen offset:64 sc1
    buffer_load_dwordx4 v[204:207], v14, s[24:27], s54 offen offset:80 sc1
    s_waitcnt lgkmcnt(2)
    v_mfma_f32_32x32x16_bf16 v[48:63], v[216:219], v[240:243], v[48:63]
    ds_read_b128 v[252:255], v2 offset:27648
    s_waitcnt lgkmcnt(2)
    v_mfma_f32_32x32x16_bf16 v[48:63], v[220:223], v[244:247], v[48:63]
    ds_read_b128 v[240:243], v2 offset:18432
    s_waitcnt lgkmcnt(2)
    v_mfma_f32_32x32x16_bf16 v[48:63], v[232:235], v[248:251], v[48:63]
    ds_read_b128 v[244:247], v2 offset:19456
    s_waitcnt lgkmcnt(2)
    v_mfma_f32_32x32x16_bf16 v[48:63], v[236:239], v[252:255], v[48:63]
    ds_read_b128 v[248:251], v2 offset:10240
    s_waitcnt lgkmcnt(2)
    v_mfma_f32_32x32x16_bf16 v[80:95], v[216:219], v[240:243], v[80:95]
    ds_read_b128 v[252:255], v2 offset:11264
    s_waitcnt lgkmcnt(2)
    v_mfma_f32_32x32x16_bf16 v[80:95], v[220:223], v[244:247], v[80:95]
    ds_read_b128 v[240:243], v2 offset:14336
    s_waitcnt lgkmcnt(2)
    v_mfma_f32_32x32x16_bf16 v[80:95], v[232:235], v[248:251], v[80:95]
    ds_read_b128 v[244:247], v2 offset:15360
    s_waitcnt lgkmcnt(2)
    v_mfma_f32_32x32x16_bf16 v[80:95], v[236:239], v[252:255], v[80:95]
    ds_read_b128 v[248:251], v2 offset:30720
    s_waitcnt lgkmcnt(2)
    v_mfma_f32_32x32x16_bf16 v[64:79], v[216:219], v[240:243], v[64:79]
    ds_read_b128 v[252:255], v2 offset:31744
    s_waitcnt lgkmcnt(2)
    v_mfma_f32_32x32x16_bf16 v[64:79], v[220:223], v[244:247], v[64:79]
    ds_read_b128 v[240:243], v2 offset:22528
    s_nop 7
    s_waitcnt lgkmcnt(2)
    v_mfma_f32_32x32x16_bf16 v[64:79], v[232:235], v[248:251], v[64:79]
    ds_read_b128 v[244:247], v2 offset:23552
    ds_read_b128 v[16:19], v15 offset:16384
    ds_read_b128 v[20:23], v15 offset:17408
    ds_read_b128 v[24:27], v15 offset:18432
    s_waitcnt lgkmcnt(2)
    v_mul_f32 v5, v48, v16
    v_mul_f32 v6, v80, v16
    v_fma_f32 v5, -v80, v17, v5
    v_fma_f32 v6, v48, v17, v6
    v_mul_f32 v7, v49, v18
    v_mul_f32 v8, v81, v18
    v_fma_f32 v7, -v81, v19, v7
    v_fma_f32 v8, v49, v19, v8
    ds_read_b128 v[28:31], v15 offset:19456
    v_cvt_pk_bf16_f32 v208, v5, v7
    v_cvt_pk_bf16_f32 v224, v6, v8
    s_waitcnt lgkmcnt(2)
    v_mfma_f32_32x32x16_bf16 v[64:79], v[236:239], v[252:255], v[64:79]
    ds_read_b128 v[248:251], v2 offset:14336
    v_mul_f32 v5, v50, v20
    v_mul_f32 v6, v82, v20
    v_fma_f32 v5, -v82, v21, v5
    v_fma_f32 v6, v50, v21, v6
    v_mul_f32 v7, v51, v22
    v_mul_f32 v8, v83, v22
    v_fma_f32 v7, -v83, v23, v7
    v_fma_f32 v8, v51, v23, v8
    ds_read_b128 v[16:19], v15 offset:20480
    v_cvt_pk_bf16_f32 v209, v5, v7
    v_cvt_pk_bf16_f32 v225, v6, v8
    s_waitcnt lgkmcnt(3)
    v_mul_f32 v5, v52, v24
    v_mul_f32 v6, v84, v24
    v_fma_f32 v5, -v84, v25, v5
    v_fma_f32 v6, v52, v25, v6
    v_mfma_f32_32x32x16_bf16 v[96:111], v[216:219], v[240:243], v[96:111]
    ds_read_b128 v[252:255], v2 offset:15360
    v_mul_f32 v7, v53, v26
    v_mul_f32 v8, v85, v26
    v_fma_f32 v7, -v85, v27, v7
    v_fma_f32 v8, v53, v27, v8
    ds_read_b128 v[20:23], v15 offset:21504
    v_cvt_pk_bf16_f32 v210, v5, v7
    v_cvt_pk_bf16_f32 v226, v6, v8
    s_waitcnt lgkmcnt(4)
    v_mul_f32 v5, v54, v28
    v_mul_f32 v6, v86, v28
    v_fma_f32 v5, -v86, v29, v5
    v_fma_f32 v6, v54, v29, v6
    v_mul_f32 v7, v55, v30
    v_mul_f32 v8, v87, v30
    v_fma_f32 v7, -v87, v31, v7
    v_fma_f32 v8, v55, v31, v8
    v_mfma_f32_32x32x16_bf16 v[96:111], v[220:223], v[244:247], v[96:111]
    ds_read_b128 v[240:243], v2 offset:32768
    ds_read_b128 v[24:27], v15 offset:22528
    v_cvt_pk_bf16_f32 v211, v5, v7
    v_cvt_pk_bf16_f32 v227, v6, v8
    s_waitcnt lgkmcnt(4)
    v_mul_f32 v5, v56, v16
    v_mul_f32 v6, v88, v16
    v_fma_f32 v5, -v88, v17, v5
    v_fma_f32 v6, v56, v17, v6
    v_mul_f32 v7, v57, v18
    v_mul_f32 v8, v89, v18
    v_fma_f32 v7, -v89, v19, v7
    v_fma_f32 v8, v57, v19, v8
    ds_read_b128 v[28:31], v15 offset:23552
    v_cvt_pk_bf16_f32 v212, v5, v7
    v_cvt_pk_bf16_f32 v228, v6, v8
    s_waitcnt lgkmcnt(3)
    v_mfma_f32_32x32x16_bf16 v[96:111], v[232:235], v[248:251], v[96:111]
    ds_read_b128 v[244:247], v2 offset:33792
    v_mul_f32 v5, v58, v20
    v_mul_f32 v6, v90, v20
    v_fma_f32 v5, -v90, v21, v5
    v_fma_f32 v6, v58, v21, v6
    v_mul_f32 v7, v59, v22
    v_mul_f32 v8, v91, v22
    v_fma_f32 v7, -v91, v23, v7
    v_fma_f32 v8, v59, v23, v8
    v_cvt_pk_bf16_f32 v213, v5, v7
    v_cvt_pk_bf16_f32 v229, v6, v8
    s_waitcnt lgkmcnt(2)
    v_mul_f32 v5, v60, v24
    v_mul_f32 v6, v92, v24
    v_fma_f32 v5, -v92, v25, v5
    v_fma_f32 v6, v60, v25, v6
    v_mul_f32 v7, v61, v26
    v_mfma_f32_32x32x16_bf16 v[96:111], v[236:239], v[252:255], v[96:111]
    ds_read_b128 v[248:251], v2 offset:36864
    v_mul_f32 v8, v93, v26
    v_fma_f32 v7, -v93, v27, v7
    v_fma_f32 v8, v61, v27, v8
    v_cvt_pk_bf16_f32 v214, v5, v7
    v_cvt_pk_bf16_f32 v230, v6, v8
    s_waitcnt lgkmcnt(2)
    v_mul_f32 v5, v62, v28
    v_mul_f32 v6, v94, v28
    v_fma_f32 v5, -v94, v29, v5
    v_fma_f32 v6, v62, v29, v6
    v_mul_f32 v7, v63, v30
    v_mul_f32 v8, v95, v30
    v_fma_f32 v7, -v95, v31, v7
    v_fma_f32 v8, v63, v31, v8
    v_cvt_pk_bf16_f32 v215, v5, v7
    v_cvt_pk_bf16_f32 v231, v6, v8
    s_nop 1
    v_mfma_f32_32x32x16_bf16 v[112:127], v[240:243], v[208:211], 0
    ds_read_b128 v[252:255], v2 offset:37888
    s_waitcnt lgkmcnt(2)
    v_mfma_f32_32x32x16_bf16 v[112:127], v[244:247], v[212:215], v[112:127]
    ds_read_b128 v[240:243], v2 offset:34816
    s_nop 7
    s_waitcnt lgkmcnt(2)
    v_mfma_f32_32x32x16_bf16 v[112:127], v[248:251], v[224:227], v[112:127]
    ds_read_b128 v[244:247], v2 offset:35840
    ds_read_b128 v[16:19], v15 offset:24576
    ds_read_b128 v[20:23], v15 offset:25600
    ds_read_b128 v[24:27], v15 offset:26624
    s_waitcnt lgkmcnt(2)
    v_mul_f32 v5, v64, v16
    v_mul_f32 v6, v96, v16
    v_fma_f32 v5, -v96, v17, v5
    v_fma_f32 v6, v64, v17, v6
    v_mul_f32 v7, v65, v18
    v_mul_f32 v8, v97, v18
    v_fma_f32 v7, -v97, v19, v7
    v_fma_f32 v8, v65, v19, v8
    ds_read_b128 v[28:31], v15 offset:27648
    v_cvt_pk_bf16_f32 v216, v5, v7
    v_cvt_pk_bf16_f32 v232, v6, v8
    s_waitcnt lgkmcnt(2)
    v_mfma_f32_32x32x16_bf16 v[112:127], v[252:255], v[228:231], v[112:127]
    ds_read_b128 v[248:251], v2 offset:32768
    v_mul_f32 v5, v66, v20
    v_mul_f32 v6, v98, v20
    v_fma_f32 v5, -v98, v21, v5
    v_fma_f32 v6, v66, v21, v6
    v_mul_f32 v7, v67, v22
    v_mul_f32 v8, v99, v22
    v_fma_f32 v7, -v99, v23, v7
    v_fma_f32 v8, v67, v23, v8
    ds_read_b128 v[16:19], v15 offset:28672
    v_cvt_pk_bf16_f32 v217, v5, v7
    v_cvt_pk_bf16_f32 v233, v6, v8
    s_waitcnt lgkmcnt(3)
    v_mul_f32 v5, v68, v24
    v_mul_f32 v6, v100, v24
    v_fma_f32 v5, -v100, v25, v5
    v_fma_f32 v6, v68, v25, v6
    v_mfma_f32_32x32x16_bf16 v[144:159], v[240:243], v[208:211], 0
    ds_read_b128 v[252:255], v2 offset:33792
    v_mul_f32 v7, v69, v26
    v_mul_f32 v8, v101, v26
    v_fma_f32 v7, -v101, v27, v7
    v_fma_f32 v8, v69, v27, v8
    ds_read_b128 v[20:23], v15 offset:29696
    v_cvt_pk_bf16_f32 v218, v5, v7
    v_cvt_pk_bf16_f32 v234, v6, v8
    s_waitcnt lgkmcnt(4)
    v_mul_f32 v5, v70, v28
    v_mul_f32 v6, v102, v28
    v_fma_f32 v5, -v102, v29, v5
    v_fma_f32 v6, v70, v29, v6
    v_mul_f32 v7, v71, v30
    v_mul_f32 v8, v103, v30
    v_fma_f32 v7, -v103, v31, v7
    v_fma_f32 v8, v71, v31, v8
    v_mfma_f32_32x32x16_bf16 v[144:159], v[244:247], v[212:215], v[144:159]
    ds_read_b128 v[240:243], v2 offset:32768
    ds_read_b128 v[24:27], v15 offset:30720
    v_cvt_pk_bf16_f32 v219, v5, v7
    v_cvt_pk_bf16_f32 v235, v6, v8
    s_waitcnt lgkmcnt(4)
    v_mul_f32 v5, v72, v16
    v_mul_f32 v6, v104, v16
    v_fma_f32 v5, -v104, v17, v5
    v_fma_f32 v6, v72, v17, v6
    v_mul_f32 v7, v73, v18
    v_mul_f32 v8, v105, v18
    v_fma_f32 v7, -v105, v19, v7
    v_fma_f32 v8, v73, v19, v8
    ds_read_b128 v[28:31], v15 offset:31744
    v_cvt_pk_bf16_f32 v220, v5, v7
    v_cvt_pk_bf16_f32 v236, v6, v8
    s_waitcnt lgkmcnt(3)
    v_mfma_f32_32x32x16_bf16 v[144:159], v[248:251], v[224:227], v[144:159]
    ds_read_b128 v[244:247], v2 offset:33792
    v_mul_f32 v5, v74, v20
    v_mul_f32 v6, v106, v20
    v_fma_f32 v5, -v106, v21, v5
    v_fma_f32 v6, v74, v21, v6
    v_mul_f32 v7, v75, v22
    v_mul_f32 v8, v107, v22
    v_fma_f32 v7, -v107, v23, v7
    v_fma_f32 v8, v75, v23, v8
    v_cvt_pk_bf16_f32 v221, v5, v7
    v_cvt_pk_bf16_f32 v237, v6, v8
    s_waitcnt lgkmcnt(2)
    v_mul_f32 v5, v76, v24
    v_mul_f32 v6, v108, v24
    v_fma_f32 v5, -v108, v25, v5
    v_fma_f32 v6, v76, v25, v6
    v_mul_f32 v7, v77, v26
    v_mfma_f32_32x32x16_bf16 v[144:159], v[252:255], v[228:231], v[144:159]
    ds_read_b128 v[248:251], v2 offset:36864
    v_mul_f32 v8, v109, v26
    v_fma_f32 v7, -v109, v27, v7
    v_fma_f32 v8, v77, v27, v8
    v_cvt_pk_bf16_f32 v222, v5, v7
    v_cvt_pk_bf16_f32 v238, v6, v8
    s_waitcnt lgkmcnt(2)
    v_mul_f32 v5, v78, v28
    v_mul_f32 v6, v110, v28
    v_fma_f32 v5, -v110, v29, v5
    v_fma_f32 v6, v78, v29, v6
    v_mul_f32 v7, v79, v30
    v_mul_f32 v8, v111, v30
    v_fma_f32 v7, -v111, v31, v7
    v_fma_f32 v8, v79, v31, v8
    v_cvt_pk_bf16_f32 v223, v5, v7
    v_cvt_pk_bf16_f32 v239, v6, v8
    s_nop 1
    s_waitcnt vmcnt(0)
    v_mov_b32 v5, s62
    v_mov_b32 v6, 0
    s_mov_b64 exec, 1
    buffer_store_dword v5, v6, s[24:27], s63 offen sc1
    s_mov_b64 exec, -1
    s_add_u32 s63, s63, 8192
    v_mov_b32 v7, s62
    v_mov_b32 v8, 0
    s_mov_b64 exec, 1
    buffer_store_dword v7, v8, s[24:27], s63 offen sc1
    s_mov_b64 exec, -1
    v_mfma_f32_32x32x16_bf16 v[128:143], v[240:243], v[216:219], 0
    ds_read_b128 v[252:255], v2 offset:37888
    s_waitcnt lgkmcnt(2)
    v_mfma_f32_32x32x16_bf16 v[128:143], v[244:247], v[220:223], v[128:143]
    ds_read_b128 v[240:243], v2 offset:34816
    s_nop 7
    s_waitcnt lgkmcnt(2)
    v_mfma_f32_32x32x16_bf16 v[128:143], v[248:251], v[232:235], v[128:143]
    ds_read_b128 v[244:247], v2 offset:35840
    v_pk_mul_f32 v[112:113], v[112:113], v[176:177]
    v_pk_mul_f32 v[114:115], v[114:115], v[178:179]
    v_pk_mul_f32 v[116:117], v[116:117], v[180:181]
    v_pk_mul_f32 v[118:119], v[118:119], v[182:183]
    v_pk_mul_f32 v[120:121], v[120:121], v[184:185]
    v_pk_mul_f32 v[122:123], v[122:123], v[186:187]
    s_waitcnt lgkmcnt(2)
    v_mfma_f32_32x32x16_bf16 v[128:143], v[252:255], v[236:239], v[128:143]
    ds_read_b128 v[248:251], v2 offset:32768
    v_pk_mul_f32 v[124:125], v[124:125], v[188:189]
    v_pk_mul_f32 v[126:127], v[126:127], v[190:191]
    v_cvt_pk_bf16_f32 v48, v112, v113
    v_cvt_pk_bf16_f32 v49, v114, v115
    v_cvt_pk_bf16_f32 v50, v116, v117
    v_cvt_pk_bf16_f32 v51, v118, v119
    s_waitcnt lgkmcnt(2)
    v_mfma_f32_32x32x16_bf16 v[160:175], v[240:243], v[216:219], 0
    ds_read_b128 v[252:255], v2 offset:33792
    buffer_store_dwordx4 v[48:51], v13, s[24:27], s52 offen offset:0 sc1
    v_cvt_pk_bf16_f32 v52, v120, v121
    v_cvt_pk_bf16_f32 v53, v122, v123
    v_cvt_pk_bf16_f32 v54, v124, v125
    v_cvt_pk_bf16_f32 v55, v126, v127
    buffer_store_dwordx4 v[52:55], v13, s[24:27], s52 offen offset:2048 sc1
    s_waitcnt lgkmcnt(2)
    v_mfma_f32_32x32x16_bf16 v[160:175], v[244:247], v[220:223], v[160:175]
    v_pk_mul_f32 v[144:145], v[144:145], v[176:177]
    v_pk_mul_f32 v[146:147], v[146:147], v[178:179]
    v_pk_mul_f32 v[148:149], v[148:149], v[180:181]
    v_pk_mul_f32 v[150:151], v[150:151], v[182:183]
    v_pk_mul_f32 v[152:153], v[152:153], v[184:185]
    v_pk_mul_f32 v[154:155], v[154:155], v[186:187]
    s_waitcnt lgkmcnt(1)
    v_mfma_f32_32x32x16_bf16 v[160:175], v[248:251], v[232:235], v[160:175]
    v_pk_mul_f32 v[156:157], v[156:157], v[188:189]
    v_pk_mul_f32 v[158:159], v[158:159], v[190:191]
    v_cvt_pk_bf16_f32 v56, v144, v145
    v_cvt_pk_bf16_f32 v57, v146, v147
    v_cvt_pk_bf16_f32 v58, v148, v149
    v_cvt_pk_bf16_f32 v59, v150, v151
    s_waitcnt lgkmcnt(0)
    v_mfma_f32_32x32x16_bf16 v[160:175], v[252:255], v[236:239], v[160:175]
    buffer_store_dwordx4 v[56:59], v13, s[24:27], s55 offen offset:0 sc1
    v_cvt_pk_bf16_f32 v60, v152, v153
    v_cvt_pk_bf16_f32 v61, v154, v155
    v_cvt_pk_bf16_f32 v62, v156, v157
    v_cvt_pk_bf16_f32 v63, v158, v159
    buffer_store_dwordx4 v[60:63], v13, s[24:27], s55 offen offset:2048 sc1
    s_nop 1
    s_nop 11
    v_pk_mul_f32 v[128:129], v[128:129], v[192:193]
    v_pk_mul_f32 v[130:131], v[130:131], v[194:195]
    v_pk_mul_f32 v[132:133], v[132:133], v[196:197]
    v_pk_mul_f32 v[134:135], v[134:135], v[198:199]
    v_pk_mul_f32 v[136:137], v[136:137], v[200:201]
    v_pk_mul_f32 v[138:139], v[138:139], v[202:203]
    v_pk_mul_f32 v[140:141], v[140:141], v[204:205]
    v_pk_mul_f32 v[142:143], v[142:143], v[206:207]
    v_cvt_pk_bf16_f32 v64, v128, v129
    v_cvt_pk_bf16_f32 v65, v130, v131
    v_cvt_pk_bf16_f32 v66, v132, v133
    v_cvt_pk_bf16_f32 v67, v134, v135
    buffer_store_dwordx4 v[64:67], v13, s[24:27], s52 offen offset:1024 sc1
    v_cvt_pk_bf16_f32 v68, v136, v137
    v_cvt_pk_bf16_f32 v69, v138, v139
    v_cvt_pk_bf16_f32 v70, v140, v141
    v_cvt_pk_bf16_f32 v71, v142, v143
    buffer_store_dwordx4 v[68:71], v13, s[24:27], s52 offen offset:3072 sc1
    v_pk_mul_f32 v[160:161], v[160:161], v[192:193]
    v_pk_mul_f32 v[162:163], v[162:163], v[194:195]
    v_pk_mul_f32 v[164:165], v[164:165], v[196:197]
    v_pk_mul_f32 v[166:167], v[166:167], v[198:199]
    v_pk_mul_f32 v[168:169], v[168:169], v[200:201]
    v_pk_mul_f32 v[170:171], v[170:171], v[202:203]
    v_pk_mul_f32 v[172:173], v[172:173], v[204:205]
    v_pk_mul_f32 v[174:175], v[174:175], v[206:207]
    v_cvt_pk_bf16_f32 v72, v160, v161
    v_cvt_pk_bf16_f32 v73, v162, v163
    v_cvt_pk_bf16_f32 v74, v164, v165
    v_cvt_pk_bf16_f32 v75, v166, v167
    buffer_store_dwordx4 v[72:75], v13, s[24:27], s55 offen offset:1024 sc1
    v_cvt_pk_bf16_f32 v76, v168, v169
    v_cvt_pk_bf16_f32 v77, v170, v171
    v_cvt_pk_bf16_f32 v78, v172, v173
    v_cvt_pk_bf16_f32 v79, v174, v175
    buffer_store_dwordx4 v[76:79], v13, s[24:27], s55 offen offset:3072 sc1
K2_ZDONE:
    s_lshl_b32 s52, s37, 2
    s_add_u32 s52, s52, 36987136
    v_mov_b32 v5, 40960
    v_mov_b32 v6, 1
    s_waitcnt vmcnt(0)
    s_mov_b64 exec, 1
    ds_add_rtn_u32 v7, v5, v6
    s_waitcnt lgkmcnt(0)
    s_mov_b64 exec, -1
    v_readfirstlane_b32 s53, v7
    s_cmp_lt_u32 s37, 33
    s_cselect_b32 s54, 4, 3
    s_cmp_lg_u32 s53, s54
    s_cbranch_scc1 K2_FIN
    v_mov_b32 v5, s62
    v_mov_b32 v6, 0
    s_mov_b64 exec, 1
    buffer_store_dword v5, v6, s[24:27], s52 offen sc1
    s_mov_b64 exec, -1
    s_branch K2_FIN
K2_FIN:
K2_END:
    s_endpgm
.section .rodata,"a"
.p2align 6
.amdhsa_kernel gated_mix__spectral_gfnet__glu_gated_reglu__prompt_kernel
  .amdhsa_next_free_vgpr 256
  .amdhsa_next_free_sgpr 102
  .amdhsa_accum_offset 256
  .amdhsa_group_segment_fixed_size 0
  .amdhsa_kernarg_size 88
  .amdhsa_user_sgpr_count 2
  .amdhsa_user_sgpr_kernarg_segment_ptr 1
  .amdhsa_system_sgpr_workgroup_id_x 1
.end_amdhsa_kernel
```
